```python
import torch

def _softmax(x, axis=-1):
    return torch.softmax(x, dim=axis)
def _gelu(x):
    return torch.nn.functional.gelu(x, approximate="tanh")
def _silu(x):
    return torch.nn.functional.silu(x)
def _sigmoid(x):
    return torch.sigmoid(x)
def _layernorm(x, axis=-1, eps=1e-5):
    m = x.mean(dim=axis, keepdim=True)
    v = x.var(dim=axis, keepdim=True, unbiased=False)
    return (x - m) / torch.sqrt(v + eps)
def _scatter_add(tgt, idx, src, axis=0):
    return tgt.clone().index_add_(axis, idx, src)
def _segment_sum(src, seg, n):
    out = torch.zeros((n,) + src.shape[1:], dtype=src.dtype)
    return out.index_add_(0, seg, src)
def _pad(x, pw):
    flat = tuple(v for pair in reversed(pw) for v in pair)
    return torch.nn.functional.pad(x, flat)

kernel_name = 'standalone__linear_kernel_rfa__decode'

def setup_inputs():

    _w = (lambda a: (lambda t: t.to(torch.bfloat16) if t.is_floating_point() else t)(torch.as_tensor(a)))
    B, H, Sq, Sk, D, M = 2, 16, 1, 16384, 256, 16
    return {
        "q": _w((lambda *s: torch.randn(*s, dtype=torch.bfloat16) * 0.4)(B, H, Sq, D)),
        "k": _w((lambda *s: torch.randn(*s, dtype=torch.bfloat16) * 1.6)(B, H, Sk, D)),
        "v": _w((lambda *s: torch.randn(*s, dtype=torch.bfloat16) * 1.6)(B, H, Sk, D)),
        "omega": _w((lambda *s: torch.randn(*s, dtype=torch.bfloat16) * 1.6)(M, D)),
    }

def reference(q, k, v, omega):
    d = q.shape[-1]
    m = omega.shape[0]
    scale = float(d) ** -0.25
    qs = q * scale
    ks = k * scale
    q_proj = torch.einsum("bhsd,md->bhsm", qs, omega)
    k_proj = torch.einsum("bhsd,md->bhsm", ks, omega)
    q_sq = 0.5 * torch.einsum("bhsd,bhsd->bhs", qs, qs)[..., None]
    k_sq = 0.5 * torch.einsum("bhsd,bhsd->bhs", ks, ks)[..., None]
    inv_sqrt_m = float(m) ** -0.5
    phi_q = torch.exp(q_proj - q_sq) * inv_sqrt_m + 1e-6
    phi_k = torch.exp(k_proj - k_sq) * inv_sqrt_m + 1e-6
    kv = torch.einsum("bhsm,bhsd->bhmd", phi_k, v)
    z  = torch.einsum("bhsm->bhm", phi_k)
    num = torch.einsum("bhqm,bhmd->bhqd", phi_q, kv)
    den = torch.einsum("bhqm,bhm->bhq", phi_q, z)[..., None] + 1e-6
    return num / den
```

```asm
; @launch grid=(256,1,1) block=(256,1,1) lds=126464
.amdgcn_target "amdgcn-amd-amdhsa--gfx950"
.text
.p2align 12
.rept 832
  s_endpgm
.endr
.globl standalone__linear_kernel_rfa__decode_kernel
.p2align 8
.type standalone__linear_kernel_rfa__decode_kernel,@function
standalone__linear_kernel_rfa__decode_kernel:
  s_load_dwordx8 s[16:23], s[0:1], 0
  s_load_dwordx4 s[24:27], s[0:1], 32
  s_load_dwordx2 s[28:29], s[0:1], 48
  s_cmp_ge_u32 s2, 256
  s_cbranch_scc1 L_end
  v_lshrrev_b32 v1, 6, v0
  v_and_b32 v0, 63, v0
  v_readfirstlane_b32 s32, v1
  s_bitcmp1_b32 s2, 0
  s_cselect_b32 s36, 0x2281600, 0
  s_bitcmp1_b32 s2, 1
  s_cselect_b32 s38, 0x8cc1400, 0
  s_xor_b32 s36, s36, s38
  s_bitcmp1_b32 s2, 2
  s_cselect_b32 s38, 0xd490c00, 0
  s_xor_b32 s36, s36, s38
  s_bitcmp1_b32 s2, 3
  s_cselect_b32 s38, 0x40f2000, 0
  s_xor_b32 s36, s36, s38
  s_bitcmp1_b32 s2, 4
  s_cselect_b32 s38, 0x4f3c00, 0
  s_xor_b32 s36, s36, s38
  s_bitcmp1_b32 s2, 5
  s_cselect_b32 s38, 0xc3400, 0
  s_xor_b32 s36, s36, s38
  s_bitcmp1_b32 s2, 6
  s_cselect_b32 s38, 0xc4e0200, 0
  s_xor_b32 s36, s36, s38
  s_bitcmp1_b32 s2, 7
  s_cselect_b32 s38, 0x193a00, 0
  s_xor_b32 s36, s36, s38
  v_lshrrev_b32 v1, 5, v0
  v_and_b32 v2, 31, v0
  v_xor_b32 v2, v2, v1
  v_lshlrev_b32 v2, 4, v2
  s_and_b32 s39, s36, 0x0f800000
  s_and_b32 s36, s36, 0x7fffff
  s_mov_b32 s6, 0x800000
  s_mov_b32 s7, 0x20000
  v_lshlrev_b32 v41, 2, v0
  v_add_u32 v41, 124928, v41
  s_cmp_lg_u32 s32, 0
  s_cbranch_scc0 L_loader
  v_mov_b32 v46, 0
  ds_write2st64_b32 v41, v46, v46 offset0:0 offset1:1
  ds_write2st64_b32 v41, v46, v46 offset0:2 offset1:3
  ds_write2st64_b32 v41, v46, v46 offset0:4 offset1:5
  s_cmp_eq_u32 s32, 1
  s_cbranch_scc1 L_pa0
  s_cmp_eq_u32 s32, 2
  s_cbranch_scc1 L_pa1
  s_branch L_pa2
L_bar:
  s_waitcnt lgkmcnt(0)
  s_barrier
  s_lshr_b32 s38, s39, 14
  s_lshr_b32 s40, s39, 10
  s_load_dword s48, s[22:23], 0
  s_load_dword s49, s[16:17], s38
  s_load_dword s50, s[28:29], s40
  s_branch L_consumer
L_loader:
  s_setprio 3
  v_mul_u32_u24 v4, 0x42400, v1
  v_or_b32 v4, v4, v2
  v_xor_b32 v88, s36, v4
  s_mov_b32 m0, 0
  s_waitcnt lgkmcnt(0)
  s_add_u32 s4, s18, s39
  s_addc_u32 s5, s19, 0
  buffer_load_dwordx4 v88, s[4:7], 0 offen nt lds
  s_addk_i32 m0, 1024
  v_xor_b32 v89, 0x482220, v88
  buffer_load_dwordx4 v89, s[4:7], 0 offen nt lds
  s_addk_i32 m0, 1024
  v_xor_b32 v90, 0x8040, v88
  buffer_load_dwordx4 v90, s[4:7], 0 offen nt lds
  s_addk_i32 m0, 1024
  v_xor_b32 v91, 0x48a260, v88
  buffer_load_dwordx4 v91, s[4:7], 0 offen nt lds
  s_addk_i32 m0, 1024
  v_xor_b32 v92, 0x280280, v88
  buffer_load_dwordx4 v92, s[4:7], 0 offen nt lds
  s_addk_i32 m0, 1024
  v_xor_b32 v93, 0x6020a0, v88
  buffer_load_dwordx4 v93, s[4:7], 0 offen nt lds
  s_addk_i32 m0, 1024
  v_xor_b32 v94, 0x2882c0, v88
  buffer_load_dwordx4 v94, s[4:7], 0 offen nt lds
  s_addk_i32 m0, 1024
  v_xor_b32 v95, 0x60a0e0, v88
  buffer_load_dwordx4 v95, s[4:7], 0 offen nt lds
  s_addk_i32 m0, 1024
  v_xor_b32 v96, 0xce000, v88
  buffer_load_dwordx4 v96, s[4:7], 0 offen nt lds
  s_addk_i32 m0, 1024
  v_xor_b32 v97, 0x44c220, v88
  buffer_load_dwordx4 v97, s[4:7], 0 offen nt lds
  s_addk_i32 m0, 1024
  v_xor_b32 v98, 0xc6040, v88
  buffer_load_dwordx4 v98, s[4:7], 0 offen nt lds
  s_addk_i32 m0, 1024
  v_xor_b32 v99, 0x444260, v88
  buffer_load_dwordx4 v99, s[4:7], 0 offen nt lds
  s_addk_i32 m0, 1024
  v_xor_b32 v100, 0x24e280, v88
  buffer_load_dwordx4 v100, s[4:7], 0 offen nt lds
  s_addk_i32 m0, 1024
  v_xor_b32 v101, 0x6cc0a0, v88
  buffer_load_dwordx4 v101, s[4:7], 0 offen nt lds
  s_addk_i32 m0, 1024
  v_xor_b32 v102, 0x2462c0, v88
  buffer_load_dwordx4 v102, s[4:7], 0 offen nt lds
  s_addk_i32 m0, 1024
  v_xor_b32 v103, 0x6c40e0, v88
  buffer_load_dwordx4 v103, s[4:7], 0 offen nt lds
  s_addk_i32 m0, 1024
  s_mov_b32 s33, 0
  s_mov_b32 s72, 0xce000
  v_xor_b32 v5, 0x482220, v4
  v_xor_b32 v6, 0x8040, v4
  v_xor_b32 v7, 0x48a260, v4
  v_xor_b32 v8, 0x280280, v4
  v_xor_b32 v9, 0x6020a0, v4
  v_xor_b32 v10, 0x2882c0, v4
  v_xor_b32 v11, 0x60a0e0, v4
  s_mov_b32 s12, s4
  s_mov_b32 s13, s5
  s_add_u32 s14, s20, s39
  s_addc_u32 s15, s21, 0
  v_mov_b32 v60, s36
  v_bfe_i32 v61, v0, 0, 1
  v_and_b32 v61, 0x400000, v61
  v_xor_b32 v60, v60, v61
  v_bfe_i32 v61, v0, 1, 1
  v_and_b32 v61, 0x10200, v61
  v_xor_b32 v60, v60, v61
  v_bfe_i32 v61, v0, 2, 1
  v_and_b32 v61, 0x4d0600, v61
  v_xor_b32 v60, v60, v61
  v_bfe_i32 v61, v0, 3, 1
  v_and_b32 v61, 0x222400, v61
  v_xor_b32 v60, v60, v61
  v_bfe_i32 v61, v0, 4, 1
  v_and_b32 v61, 0x5a3600, v61
  v_xor_b32 v60, v60, v61
  v_bfe_i32 v61, v0, 5, 1
  v_and_b32 v61, 0x41ae00, v61
  v_xor_b32 v60, v60, v61
  v_mov_b32 v44, 2
  v_mov_b32 v52, 0
  v_mov_b32 v53, 0
  v_mov_b32 v49, 0
  s_getreg_b32 s59, hwreg(HW_REG_HW_ID, 8, 4)
  s_getreg_b32 s58, hwreg(HW_REG_HW_ID, 13, 1)
  s_sub_i32 s59, s59, s58
  s_max_i32 s59, s59, 0
  s_mul_i32 s59, s59, 2
  s_getreg_b32 s58, hwreg(HW_REG_XCC_ID, 0, 1)
  s_cmp_eq_u32 s58, 0
  s_cselect_b32 s58, 20, 0
  s_add_u32 s58, s58, 256
  s_add_u32 s70, s59, s58
  s_mov_b32 s58, 0
  s_barrier
L_ld:
  s_add_u32 s33, s33, 1
  s_cmp_ge_u32 s33, 127
  s_cbranch_scc1 L_drain
  s_cmp_eq_u32 m0, 98304
  s_cselect_b32 m0, 0, m0
  s_bitcmp1_b32 s33, 6
  s_cselect_b32 s4, s14, s12
  s_cselect_b32 s5, s15, s13
  v_readlane_b32 s35, v60, s33
  s_sub_i32 s47, s33, 6
L_ldf:
  s_waitcnt lgkmcnt(0)
  v_min_i32 v43, v52, v53
  v_readfirstlane_b32 s38, v49
  v_readfirstlane_b32 s37, v43
  s_cmp_gt_i32 s37, s47
  s_cbranch_scc0 L_ldr
  s_add_i32 s38, s38, s70
  s_max_i32 s38, s38, 0
  s_min_i32 s38, s38, 767
  s_lshl_b32 s59, s38, 26
  s_lshr_b32 s38, s38, 6
  s_add_u32 s58, s58, s59
  s_addc_u32 s38, s38, 0
  s_cmp_eq_u32 s38, 4
  s_cbranch_scc1 L_v20
  s_cmp_eq_u32 s38, 5
  s_cbranch_scc1 L_v21
  s_cmp_eq_u32 s38, 3
  s_cbranch_scc1 L_v19
  s_cmp_eq_u32 s38, 6
  s_cbranch_scc1 L_v22
  s_cmp_eq_u32 s38, 2
  s_cbranch_scc1 L_v18
  s_cmp_eq_u32 s38, 7
  s_cbranch_scc1 L_v23
  s_cmp_eq_u32 s38, 1
  s_cbranch_scc1 L_v17
  s_cmp_eq_u32 s38, 8
  s_cbranch_scc1 L_v24
  s_cmp_eq_u32 s38, 0
  s_cbranch_scc1 L_v16
  s_cmp_eq_u32 s38, 9
  s_cbranch_scc1 L_v25
  s_cmp_eq_u32 s38, 10
  s_cbranch_scc1 L_v26
  s_cmp_eq_u32 s38, 11
  s_cbranch_scc1 L_v27
  s_branch L_v28
L_ldr:
  ds_read2_b32 v[52:53], v41 offset0:64 offset1:128
  s_branch L_ldf
L_pa2:
  s_branch L_bar
L_v20:
  v_xor_b32 v88, s35, v4
  s_waitcnt vmcnt(19)
  buffer_load_dwordx4 v88, s[4:7], 0 offen nt lds
  s_addk_i32 m0, 1024
  v_xor_b32 v89, s35, v5
  s_waitcnt vmcnt(19)
  buffer_load_dwordx4 v89, s[4:7], 0 offen nt lds
  s_addk_i32 m0, 1024
  v_xor_b32 v90, s35, v6
  s_waitcnt vmcnt(19)
  buffer_load_dwordx4 v90, s[4:7], 0 offen nt lds
  s_addk_i32 m0, 1024
  v_xor_b32 v91, s35, v7
  v_add_u32 v43, -2, v44
  s_waitcnt vmcnt(19)
  buffer_load_dwordx4 v91, s[4:7], 0 offen nt lds
  s_addk_i32 m0, 1024
  ds_max_i32 v41, v43
  v_xor_b32 v92, s35, v8
  s_waitcnt vmcnt(19)
  buffer_load_dwordx4 v92, s[4:7], 0 offen nt lds
  s_addk_i32 m0, 1024
  v_xor_b32 v93, s35, v9
  s_waitcnt vmcnt(19)
  buffer_load_dwordx4 v93, s[4:7], 0 offen nt lds
  s_addk_i32 m0, 1024
  v_xor_b32 v94, s35, v10
  s_waitcnt vmcnt(19)
  buffer_load_dwordx4 v94, s[4:7], 0 offen nt lds
  s_addk_i32 m0, 1024
  ds_read2_b32 v[52:53], v41 offset0:64 offset1:128
  ds_read_b32 v49, v41 offset:768
  v_xor_b32 v95, s35, v11
  s_waitcnt vmcnt(19)
  buffer_load_dwordx4 v95, s[4:7], 0 offen nt lds
  s_addk_i32 m0, 1024
  s_xor_b32 s35, s35, s72
  v_add_u32 v44, 1, v44
  s_bitcmp1_b32 m0, 13
  s_cbranch_scc1 L_v20
  s_branch L_ld
L_v21:
  v_xor_b32 v88, s35, v4
  s_waitcnt vmcnt(20)
  buffer_load_dwordx4 v88, s[4:7], 0 offen nt lds
  s_addk_i32 m0, 1024
  v_xor_b32 v89, s35, v5
  s_waitcnt vmcnt(20)
  buffer_load_dwordx4 v89, s[4:7], 0 offen nt lds
  s_addk_i32 m0, 1024
  v_xor_b32 v90, s35, v6
  s_waitcnt vmcnt(20)
  buffer_load_dwordx4 v90, s[4:7], 0 offen nt lds
  s_addk_i32 m0, 1024
  v_xor_b32 v91, s35, v7
  s_waitcnt vmcnt(20)
  buffer_load_dwordx4 v91, s[4:7], 0 offen nt lds
  s_addk_i32 m0, 1024
  v_xor_b32 v92, s35, v8
  v_add_u32 v43, -2, v44
  s_waitcnt vmcnt(20)
  buffer_load_dwordx4 v92, s[4:7], 0 offen nt lds
  s_addk_i32 m0, 1024
  ds_max_i32 v41, v43
  v_xor_b32 v93, s35, v9
  s_waitcnt vmcnt(20)
  buffer_load_dwordx4 v93, s[4:7], 0 offen nt lds
  s_addk_i32 m0, 1024
  v_xor_b32 v94, s35, v10
  s_waitcnt vmcnt(20)
  buffer_load_dwordx4 v94, s[4:7], 0 offen nt lds
  s_addk_i32 m0, 1024
  ds_read2_b32 v[52:53], v41 offset0:64 offset1:128
  ds_read_b32 v49, v41 offset:768
  v_xor_b32 v95, s35, v11
  s_waitcnt vmcnt(20)
  buffer_load_dwordx4 v95, s[4:7], 0 offen nt lds
  s_addk_i32 m0, 1024
  s_xor_b32 s35, s35, s72
  v_add_u32 v44, 1, v44
  s_bitcmp1_b32 m0, 13
  s_cbranch_scc1 L_v21
  s_branch L_ld
L_v19:
  v_xor_b32 v88, s35, v4
  s_waitcnt vmcnt(18)
  buffer_load_dwordx4 v88, s[4:7], 0 offen nt lds
  s_addk_i32 m0, 1024
  v_xor_b32 v89, s35, v5
  s_waitcnt vmcnt(18)
  buffer_load_dwordx4 v89, s[4:7], 0 offen nt lds
  s_addk_i32 m0, 1024
  v_xor_b32 v90, s35, v6
  v_add_u32 v43, -2, v44
  s_waitcnt vmcnt(18)
  buffer_load_dwordx4 v90, s[4:7], 0 offen nt lds
  s_addk_i32 m0, 1024
  ds_max_i32 v41, v43
  v_xor_b32 v91, s35, v7
  s_waitcnt vmcnt(18)
  buffer_load_dwordx4 v91, s[4:7], 0 offen nt lds
  s_addk_i32 m0, 1024
  v_xor_b32 v92, s35, v8
  s_waitcnt vmcnt(18)
  buffer_load_dwordx4 v92, s[4:7], 0 offen nt lds
  s_addk_i32 m0, 1024
  v_xor_b32 v93, s35, v9
  s_waitcnt vmcnt(18)
  buffer_load_dwordx4 v93, s[4:7], 0 offen nt lds
  s_addk_i32 m0, 1024
  v_xor_b32 v94, s35, v10
  s_waitcnt vmcnt(18)
  buffer_load_dwordx4 v94, s[4:7], 0 offen nt lds
  s_addk_i32 m0, 1024
  ds_read2_b32 v[52:53], v41 offset0:64 offset1:128
  ds_read_b32 v49, v41 offset:768
  v_xor_b32 v95, s35, v11
  s_waitcnt vmcnt(18)
  buffer_load_dwordx4 v95, s[4:7], 0 offen nt lds
  s_addk_i32 m0, 1024
  s_xor_b32 s35, s35, s72
  v_add_u32 v44, 1, v44
  s_bitcmp1_b32 m0, 13
  s_cbranch_scc1 L_v19
  s_branch L_ld
L_v22:
  v_xor_b32 v88, s35, v4
  s_waitcnt vmcnt(21)
  buffer_load_dwordx4 v88, s[4:7], 0 offen nt lds
  s_addk_i32 m0, 1024
  v_xor_b32 v89, s35, v5
  s_waitcnt vmcnt(21)
  buffer_load_dwordx4 v89, s[4:7], 0 offen nt lds
  s_addk_i32 m0, 1024
  v_xor_b32 v90, s35, v6
  s_waitcnt vmcnt(21)
  buffer_load_dwordx4 v90, s[4:7], 0 offen nt lds
  s_addk_i32 m0, 1024
  v_xor_b32 v91, s35, v7
  s_waitcnt vmcnt(21)
  buffer_load_dwordx4 v91, s[4:7], 0 offen nt lds
  s_addk_i32 m0, 1024
  v_xor_b32 v92, s35, v8
  s_waitcnt vmcnt(21)
  buffer_load_dwordx4 v92, s[4:7], 0 offen nt lds
  s_addk_i32 m0, 1024
  v_xor_b32 v93, s35, v9
  v_add_u32 v43, -2, v44
  s_waitcnt vmcnt(21)
  buffer_load_dwordx4 v93, s[4:7], 0 offen nt lds
  s_addk_i32 m0, 1024
  ds_max_i32 v41, v43
  v_xor_b32 v94, s35, v10
  s_waitcnt vmcnt(21)
  buffer_load_dwordx4 v94, s[4:7], 0 offen nt lds
  s_addk_i32 m0, 1024
  ds_read2_b32 v[52:53], v41 offset0:64 offset1:128
  ds_read_b32 v49, v41 offset:768
  v_xor_b32 v95, s35, v11
  s_waitcnt vmcnt(21)
  buffer_load_dwordx4 v95, s[4:7], 0 offen nt lds
  s_addk_i32 m0, 1024
  s_xor_b32 s35, s35, s72
  v_add_u32 v44, 1, v44
  s_bitcmp1_b32 m0, 13
  s_cbranch_scc1 L_v22
  s_branch L_ld
L_pb0:
  s_branch L_back
L_v18:
  v_xor_b32 v88, s35, v4
  s_waitcnt vmcnt(17)
  buffer_load_dwordx4 v88, s[4:7], 0 offen nt lds
  s_addk_i32 m0, 1024
  v_xor_b32 v89, s35, v5
  v_add_u32 v43, -2, v44
  s_waitcnt vmcnt(17)
  buffer_load_dwordx4 v89, s[4:7], 0 offen nt lds
  s_addk_i32 m0, 1024
  ds_max_i32 v41, v43
  v_xor_b32 v90, s35, v6
  s_waitcnt vmcnt(17)
  buffer_load_dwordx4 v90, s[4:7], 0 offen nt lds
  s_addk_i32 m0, 1024
  v_xor_b32 v91, s35, v7
  s_waitcnt vmcnt(17)
  buffer_load_dwordx4 v91, s[4:7], 0 offen nt lds
  s_addk_i32 m0, 1024
  v_xor_b32 v92, s35, v8
  s_waitcnt vmcnt(17)
  buffer_load_dwordx4 v92, s[4:7], 0 offen nt lds
  s_addk_i32 m0, 1024
  v_xor_b32 v93, s35, v9
  s_waitcnt vmcnt(17)
  buffer_load_dwordx4 v93, s[4:7], 0 offen nt lds
  s_addk_i32 m0, 1024
  v_xor_b32 v94, s35, v10
  s_waitcnt vmcnt(17)
  buffer_load_dwordx4 v94, s[4:7], 0 offen nt lds
  s_addk_i32 m0, 1024
  ds_read2_b32 v[52:53], v41 offset0:64 offset1:128
  ds_read_b32 v49, v41 offset:768
  v_xor_b32 v95, s35, v11
  s_waitcnt vmcnt(17)
  buffer_load_dwordx4 v95, s[4:7], 0 offen nt lds
  s_addk_i32 m0, 1024
  s_xor_b32 s35, s35, s72
  v_add_u32 v44, 1, v44
  s_bitcmp1_b32 m0, 13
  s_cbranch_scc1 L_v18
  s_branch L_ld
L_v23:
  v_xor_b32 v88, s35, v4
  s_waitcnt vmcnt(22)
  buffer_load_dwordx4 v88, s[4:7], 0 offen nt lds
  s_addk_i32 m0, 1024
  v_xor_b32 v89, s35, v5
  s_waitcnt vmcnt(22)
  buffer_load_dwordx4 v89, s[4:7], 0 offen nt lds
  s_addk_i32 m0, 1024
  v_xor_b32 v90, s35, v6
  s_waitcnt vmcnt(22)
  buffer_load_dwordx4 v90, s[4:7], 0 offen nt lds
  s_addk_i32 m0, 1024
  v_xor_b32 v91, s35, v7
  s_waitcnt vmcnt(22)
  buffer_load_dwordx4 v91, s[4:7], 0 offen nt lds
  s_addk_i32 m0, 1024
  v_xor_b32 v92, s35, v8
  s_waitcnt vmcnt(22)
  buffer_load_dwordx4 v92, s[4:7], 0 offen nt lds
  s_addk_i32 m0, 1024
  v_xor_b32 v93, s35, v9
  s_waitcnt vmcnt(22)
  buffer_load_dwordx4 v93, s[4:7], 0 offen nt lds
  s_addk_i32 m0, 1024
  v_xor_b32 v94, s35, v10
  v_add_u32 v43, -2, v44
  s_waitcnt vmcnt(22)
  buffer_load_dwordx4 v94, s[4:7], 0 offen nt lds
  s_addk_i32 m0, 1024
  ds_max_i32 v41, v43
  ds_read2_b32 v[52:53], v41 offset0:64 offset1:128
  ds_read_b32 v49, v41 offset:768
  v_xor_b32 v95, s35, v11
  s_waitcnt vmcnt(22)
  buffer_load_dwordx4 v95, s[4:7], 0 offen nt lds
  s_addk_i32 m0, 1024
  s_xor_b32 s35, s35, s72
  v_add_u32 v44, 1, v44
  s_bitcmp1_b32 m0, 13
  s_cbranch_scc1 L_v23
  s_branch L_ld
L_v17:
  v_xor_b32 v88, s35, v4
  v_add_u32 v43, -2, v44
  s_waitcnt vmcnt(16)
  buffer_load_dwordx4 v88, s[4:7], 0 offen nt lds
  s_addk_i32 m0, 1024
  ds_max_i32 v41, v43
  v_xor_b32 v89, s35, v5
  s_waitcnt vmcnt(16)
  buffer_load_dwordx4 v89, s[4:7], 0 offen nt lds
  s_addk_i32 m0, 1024
  v_xor_b32 v90, s35, v6
  s_waitcnt vmcnt(16)
  buffer_load_dwordx4 v90, s[4:7], 0 offen nt lds
  s_addk_i32 m0, 1024
  v_xor_b32 v91, s35, v7
  s_waitcnt vmcnt(16)
  buffer_load_dwordx4 v91, s[4:7], 0 offen nt lds
  s_addk_i32 m0, 1024
  v_xor_b32 v92, s35, v8
  s_waitcnt vmcnt(16)
  buffer_load_dwordx4 v92, s[4:7], 0 offen nt lds
  s_addk_i32 m0, 1024
  v_xor_b32 v93, s35, v9
  s_waitcnt vmcnt(16)
  buffer_load_dwordx4 v93, s[4:7], 0 offen nt lds
  s_addk_i32 m0, 1024
  v_xor_b32 v94, s35, v10
  s_waitcnt vmcnt(16)
  buffer_load_dwordx4 v94, s[4:7], 0 offen nt lds
  s_addk_i32 m0, 1024
  ds_read2_b32 v[52:53], v41 offset0:64 offset1:128
  ds_read_b32 v49, v41 offset:768
  v_xor_b32 v95, s35, v11
  s_waitcnt vmcnt(16)
  buffer_load_dwordx4 v95, s[4:7], 0 offen nt lds
  s_addk_i32 m0, 1024
  s_xor_b32 s35, s35, s72
  v_add_u32 v44, 1, v44
  s_bitcmp1_b32 m0, 13
  s_cbranch_scc1 L_v17
  s_branch L_ld
L_v24:
  v_xor_b32 v88, s35, v4
  s_waitcnt vmcnt(23)
  buffer_load_dwordx4 v88, s[4:7], 0 offen nt lds
  s_addk_i32 m0, 1024
  v_xor_b32 v89, s35, v5
  s_waitcnt vmcnt(23)
  buffer_load_dwordx4 v89, s[4:7], 0 offen nt lds
  s_addk_i32 m0, 1024
  v_xor_b32 v90, s35, v6
  s_waitcnt vmcnt(23)
  buffer_load_dwordx4 v90, s[4:7], 0 offen nt lds
  s_addk_i32 m0, 1024
  v_xor_b32 v91, s35, v7
  s_waitcnt vmcnt(23)
  buffer_load_dwordx4 v91, s[4:7], 0 offen nt lds
  s_addk_i32 m0, 1024
  v_xor_b32 v92, s35, v8
  s_waitcnt vmcnt(23)
  buffer_load_dwordx4 v92, s[4:7], 0 offen nt lds
  s_addk_i32 m0, 1024
  v_xor_b32 v93, s35, v9
  s_waitcnt vmcnt(23)
  buffer_load_dwordx4 v93, s[4:7], 0 offen nt lds
  s_addk_i32 m0, 1024
  v_xor_b32 v94, s35, v10
  s_waitcnt vmcnt(23)
  buffer_load_dwordx4 v94, s[4:7], 0 offen nt lds
  s_addk_i32 m0, 1024
  ds_read2_b32 v[52:53], v41 offset0:64 offset1:128
  ds_read_b32 v49, v41 offset:768
  v_xor_b32 v95, s35, v11
  v_add_u32 v43, -2, v44
  s_waitcnt vmcnt(23)
  buffer_load_dwordx4 v95, s[4:7], 0 offen nt lds
  s_addk_i32 m0, 1024
  ds_max_i32 v41, v43
  s_xor_b32 s35, s35, s72
  v_add_u32 v44, 1, v44
  s_bitcmp1_b32 m0, 13
  s_cbranch_scc1 L_v24
  s_branch L_ld
L_pb1:
  s_branch L_pb0
L_v16:
  v_xor_b32 v88, s35, v4
  s_waitcnt vmcnt(15)
  buffer_load_dwordx4 v88, s[4:7], 0 offen nt lds
  s_addk_i32 m0, 1024
  v_xor_b32 v89, s35, v5
  s_waitcnt vmcnt(15)
  buffer_load_dwordx4 v89, s[4:7], 0 offen nt lds
  s_addk_i32 m0, 1024
  v_xor_b32 v90, s35, v6
  s_waitcnt vmcnt(15)
  buffer_load_dwordx4 v90, s[4:7], 0 offen nt lds
  s_addk_i32 m0, 1024
  v_xor_b32 v91, s35, v7
  s_waitcnt vmcnt(15)
  buffer_load_dwordx4 v91, s[4:7], 0 offen nt lds
  s_addk_i32 m0, 1024
  v_xor_b32 v92, s35, v8
  s_waitcnt vmcnt(15)
  buffer_load_dwordx4 v92, s[4:7], 0 offen nt lds
  s_addk_i32 m0, 1024
  v_xor_b32 v93, s35, v9
  s_waitcnt vmcnt(15)
  buffer_load_dwordx4 v93, s[4:7], 0 offen nt lds
  s_addk_i32 m0, 1024
  v_xor_b32 v94, s35, v10
  s_waitcnt vmcnt(15)
  buffer_load_dwordx4 v94, s[4:7], 0 offen nt lds
  s_addk_i32 m0, 1024
  ds_read2_b32 v[52:53], v41 offset0:64 offset1:128
  ds_read_b32 v49, v41 offset:768
  v_xor_b32 v95, s35, v11
  v_add_u32 v43, -1, v44
  s_waitcnt vmcnt(15)
  buffer_load_dwordx4 v95, s[4:7], 0 offen nt lds
  s_addk_i32 m0, 1024
  ds_max_i32 v41, v43
  s_xor_b32 s35, s35, s72
  v_add_u32 v44, 1, v44
  s_bitcmp1_b32 m0, 13
  s_cbranch_scc1 L_v16
  s_branch L_ld
L_v25:
  v_xor_b32 v88, s35, v4
  v_add_u32 v43, -3, v44
  s_waitcnt vmcnt(24)
  buffer_load_dwordx4 v88, s[4:7], 0 offen nt lds
  s_addk_i32 m0, 1024
  ds_max_i32 v41, v43
  v_xor_b32 v89, s35, v5
  s_waitcnt vmcnt(24)
  buffer_load_dwordx4 v89, s[4:7], 0 offen nt lds
  s_addk_i32 m0, 1024
  v_xor_b32 v90, s35, v6
  s_waitcnt vmcnt(24)
  buffer_load_dwordx4 v90, s[4:7], 0 offen nt lds
  s_addk_i32 m0, 1024
  v_xor_b32 v91, s35, v7
  s_waitcnt vmcnt(24)
  buffer_load_dwordx4 v91, s[4:7], 0 offen nt lds
  s_addk_i32 m0, 1024
  v_xor_b32 v92, s35, v8
  s_waitcnt vmcnt(24)
  buffer_load_dwordx4 v92, s[4:7], 0 offen nt lds
  s_addk_i32 m0, 1024
  v_xor_b32 v93, s35, v9
  s_waitcnt vmcnt(24)
  buffer_load_dwordx4 v93, s[4:7], 0 offen nt lds
  s_addk_i32 m0, 1024
  v_xor_b32 v94, s35, v10
  s_waitcnt vmcnt(24)
  buffer_load_dwordx4 v94, s[4:7], 0 offen nt lds
  s_addk_i32 m0, 1024
  ds_read2_b32 v[52:53], v41 offset0:64 offset1:128
  ds_read_b32 v49, v41 offset:768
  v_xor_b32 v95, s35, v11
  s_waitcnt vmcnt(24)
  buffer_load_dwordx4 v95, s[4:7], 0 offen nt lds
  s_addk_i32 m0, 1024
  s_xor_b32 s35, s35, s72
  v_add_u32 v44, 1, v44
  s_bitcmp1_b32 m0, 13
  s_cbranch_scc1 L_v25
  s_branch L_ld
L_v26:
  v_xor_b32 v88, s35, v4
  s_waitcnt vmcnt(25)
  buffer_load_dwordx4 v88, s[4:7], 0 offen nt lds
  s_addk_i32 m0, 1024
  v_xor_b32 v89, s35, v5
  v_add_u32 v43, -3, v44
  s_waitcnt vmcnt(25)
  buffer_load_dwordx4 v89, s[4:7], 0 offen nt lds
  s_addk_i32 m0, 1024
  ds_max_i32 v41, v43
  v_xor_b32 v90, s35, v6
  s_waitcnt vmcnt(25)
  buffer_load_dwordx4 v90, s[4:7], 0 offen nt lds
  s_addk_i32 m0, 1024
  v_xor_b32 v91, s35, v7
  s_waitcnt vmcnt(25)
  buffer_load_dwordx4 v91, s[4:7], 0 offen nt lds
  s_addk_i32 m0, 1024
  v_xor_b32 v92, s35, v8
  s_waitcnt vmcnt(25)
  buffer_load_dwordx4 v92, s[4:7], 0 offen nt lds
  s_addk_i32 m0, 1024
  v_xor_b32 v93, s35, v9
  s_waitcnt vmcnt(25)
  buffer_load_dwordx4 v93, s[4:7], 0 offen nt lds
  s_addk_i32 m0, 1024
  v_xor_b32 v94, s35, v10
  s_waitcnt vmcnt(25)
  buffer_load_dwordx4 v94, s[4:7], 0 offen nt lds
  s_addk_i32 m0, 1024
  ds_read2_b32 v[52:53], v41 offset0:64 offset1:128
  ds_read_b32 v49, v41 offset:768
  v_xor_b32 v95, s35, v11
  s_waitcnt vmcnt(25)
  buffer_load_dwordx4 v95, s[4:7], 0 offen nt lds
  s_addk_i32 m0, 1024
  s_xor_b32 s35, s35, s72
  v_add_u32 v44, 1, v44
  s_bitcmp1_b32 m0, 13
  s_cbranch_scc1 L_v26
  s_branch L_ld
L_v27:
  v_xor_b32 v88, s35, v4
  s_waitcnt vmcnt(26)
  buffer_load_dwordx4 v88, s[4:7], 0 offen nt lds
  s_addk_i32 m0, 1024
  v_xor_b32 v89, s35, v5
  s_waitcnt vmcnt(26)
  buffer_load_dwordx4 v89, s[4:7], 0 offen nt lds
  s_addk_i32 m0, 1024
  v_xor_b32 v90, s35, v6
  v_add_u32 v43, -3, v44
  s_waitcnt vmcnt(26)
  buffer_load_dwordx4 v90, s[4:7], 0 offen nt lds
  s_addk_i32 m0, 1024
  ds_max_i32 v41, v43
  v_xor_b32 v91, s35, v7
  s_waitcnt vmcnt(26)
  buffer_load_dwordx4 v91, s[4:7], 0 offen nt lds
  s_addk_i32 m0, 1024
  v_xor_b32 v92, s35, v8
  s_waitcnt vmcnt(26)
  buffer_load_dwordx4 v92, s[4:7], 0 offen nt lds
  s_addk_i32 m0, 1024
  v_xor_b32 v93, s35, v9
  s_waitcnt vmcnt(26)
  buffer_load_dwordx4 v93, s[4:7], 0 offen nt lds
  s_addk_i32 m0, 1024
  v_xor_b32 v94, s35, v10
  s_waitcnt vmcnt(26)
  buffer_load_dwordx4 v94, s[4:7], 0 offen nt lds
  s_addk_i32 m0, 1024
  ds_read2_b32 v[52:53], v41 offset0:64 offset1:128
  ds_read_b32 v49, v41 offset:768
  v_xor_b32 v95, s35, v11
  s_waitcnt vmcnt(26)
  buffer_load_dwordx4 v95, s[4:7], 0 offen nt lds
  s_addk_i32 m0, 1024
  s_xor_b32 s35, s35, s72
  v_add_u32 v44, 1, v44
  s_bitcmp1_b32 m0, 13
  s_cbranch_scc1 L_v27
  s_branch L_ld
L_pb2:
  s_branch L_pb1
L_v28:
  v_xor_b32 v88, s35, v4
  s_waitcnt vmcnt(27)
  buffer_load_dwordx4 v88, s[4:7], 0 offen nt lds
  s_addk_i32 m0, 1024
  v_xor_b32 v89, s35, v5
  s_waitcnt vmcnt(27)
  buffer_load_dwordx4 v89, s[4:7], 0 offen nt lds
  s_addk_i32 m0, 1024
  v_xor_b32 v90, s35, v6
  s_waitcnt vmcnt(27)
  buffer_load_dwordx4 v90, s[4:7], 0 offen nt lds
  s_addk_i32 m0, 1024
  v_xor_b32 v91, s35, v7
  v_add_u32 v43, -3, v44
  s_waitcnt vmcnt(27)
  buffer_load_dwordx4 v91, s[4:7], 0 offen nt lds
  s_addk_i32 m0, 1024
  ds_max_i32 v41, v43
  v_xor_b32 v92, s35, v8
  s_waitcnt vmcnt(27)
  buffer_load_dwordx4 v92, s[4:7], 0 offen nt lds
  s_addk_i32 m0, 1024
  v_xor_b32 v93, s35, v9
  s_waitcnt vmcnt(27)
  buffer_load_dwordx4 v93, s[4:7], 0 offen nt lds
  s_addk_i32 m0, 1024
  v_xor_b32 v94, s35, v10
  s_waitcnt vmcnt(27)
  buffer_load_dwordx4 v94, s[4:7], 0 offen nt lds
  s_addk_i32 m0, 1024
  ds_read2_b32 v[52:53], v41 offset0:64 offset1:128
  ds_read_b32 v49, v41 offset:768
  v_xor_b32 v95, s35, v11
  s_waitcnt vmcnt(27)
  buffer_load_dwordx4 v95, s[4:7], 0 offen nt lds
  s_addk_i32 m0, 1024
  s_xor_b32 s35, s35, s72
  v_add_u32 v44, 1, v44
  s_bitcmp1_b32 m0, 13
  s_cbranch_scc1 L_v28
  s_branch L_ld
.p2align 12
L_pb3:
  s_branch L_pb2
L_drain:
  v_mov_b32 v44, 2
  s_waitcnt vmcnt(27)
  ds_write_b32 v41, v44 offset:1280
  v_mov_b32 v44, 3
  s_waitcnt vmcnt(26)
  ds_write_b32 v41, v44 offset:1280
  v_mov_b32 v44, 4
  s_waitcnt vmcnt(25)
  ds_write_b32 v41, v44 offset:1280
  v_mov_b32 v43, 251
  v_mov_b32 v44, 5
  s_waitcnt vmcnt(24)
  ds_max_i32 v41, v43
  ds_write_b32 v41, v44 offset:1280
  v_mov_b32 v44, 6
  s_waitcnt vmcnt(23)
  ds_write_b32 v41, v44 offset:1280
  v_mov_b32 v44, 7
  s_waitcnt vmcnt(22)
  ds_write_b32 v41, v44 offset:1280
  v_mov_b32 v44, 8
  s_waitcnt vmcnt(21)
  ds_write_b32 v41, v44 offset:1280
  v_mov_b32 v44, 9
  s_waitcnt vmcnt(20)
  ds_write_b32 v41, v44 offset:1280
  v_mov_b32 v44, 10
  s_waitcnt vmcnt(19)
  ds_write_b32 v41, v44 offset:1280
  v_mov_b32 v44, 11
  s_waitcnt vmcnt(18)
  ds_write_b32 v41, v44 offset:1280
  v_mov_b32 v44, 12
  s_waitcnt vmcnt(17)
  ds_write_b32 v41, v44 offset:1280
  v_mov_b32 v43, 252
  v_mov_b32 v44, 13
  s_waitcnt vmcnt(16)
  ds_max_i32 v41, v43
  ds_write_b32 v41, v44 offset:1280
  v_mov_b32 v44, 14
  s_waitcnt vmcnt(15)
  ds_write_b32 v41, v44 offset:1280
  v_mov_b32 v44, 15
  s_waitcnt vmcnt(14)
  ds_write_b32 v41, v44 offset:1280
  v_mov_b32 v44, 16
  s_waitcnt vmcnt(13)
  ds_write_b32 v41, v44 offset:1280
  v_mov_b32 v44, 17
  s_waitcnt vmcnt(12)
  ds_write_b32 v41, v44 offset:1280
  v_mov_b32 v44, 18
  s_waitcnt vmcnt(11)
  ds_write_b32 v41, v44 offset:1280
  v_mov_b32 v44, 19
  s_waitcnt vmcnt(10)
  ds_write_b32 v41, v44 offset:1280
  v_mov_b32 v44, 20
  s_waitcnt vmcnt(9)
  ds_write_b32 v41, v44 offset:1280
  v_mov_b32 v43, 253
  v_mov_b32 v44, 21
  s_waitcnt vmcnt(8)
  ds_max_i32 v41, v43
  ds_write_b32 v41, v44 offset:1280
  v_mov_b32 v44, 22
  s_waitcnt vmcnt(7)
  ds_write_b32 v41, v44 offset:1280
  v_mov_b32 v44, 23
  s_waitcnt vmcnt(6)
  ds_write_b32 v41, v44 offset:1280
  v_mov_b32 v44, 24
  s_waitcnt vmcnt(5)
  ds_write_b32 v41, v44 offset:1280
  v_mov_b32 v44, 25
  s_waitcnt vmcnt(4)
  ds_write_b32 v41, v44 offset:1280
  v_mov_b32 v44, 26
  s_waitcnt vmcnt(3)
  ds_write_b32 v41, v44 offset:1280
  v_mov_b32 v44, 27
  s_waitcnt vmcnt(2)
  ds_write_b32 v41, v44 offset:1280
  v_mov_b32 v44, 28
  s_waitcnt vmcnt(1)
  ds_write_b32 v41, v44 offset:1280
  v_mov_b32 v43, 254
  s_waitcnt vmcnt(0)
  ds_max_i32 v41, v43
  s_waitcnt lgkmcnt(0)
  s_endpgm
L_mon:
  s_bfe_u32 s31, s2, 0x20004
  s_bfe_u32 s38, s2, 0x10007
  s_lshl_b32 s38, s38, 2
  s_or_b32 s31, s31, s38
  s_lshl_b32 s38, s30, 13
  s_add_u32 s8, s28, s38
  s_addc_u32 s9, s29, 0
  s_mov_b32 s10, 8192
  s_lshl_b32 s38, s30, 3
  s_add_u32 s56, s26, s38
  s_addc_u32 s57, s27, 0
  s_add_u32 s38, s31, 0
  s_and_b32 s38, s38, 7
  s_lshl_b32 s72, s38, 10
  s_add_u32 s38, s31, 1
  s_and_b32 s38, s38, 7
  s_lshl_b32 s73, s38, 10
  s_add_u32 s38, s31, 2
  s_and_b32 s38, s38, 7
  s_lshl_b32 s74, s38, 10
  s_add_u32 s38, s31, 3
  s_and_b32 s38, s38, 7
  s_lshl_b32 s75, s38, 10
  s_add_u32 s38, s31, 4
  s_and_b32 s38, s38, 7
  s_lshl_b32 s76, s38, 10
  s_add_u32 s38, s31, 5
  s_and_b32 s38, s38, 7
  s_lshl_b32 s77, s38, 10
  s_add_u32 s38, s31, 6
  s_and_b32 s38, s38, 7
  s_lshl_b32 s78, s38, 10
  s_add_u32 s38, s31, 7
  s_and_b32 s38, s38, 7
  s_lshl_b32 s79, s38, 10
  s_waitcnt lgkmcnt(0)
  s_lshl_b32 s38, s30, 9
  s_load_dword s48, s[24:25], s38
  s_lshl_b32 s39, s30, 23
  s_lshl_b32 s38, s31, 20
  s_add_u32 s38, s38, s39
  s_load_dword s49, s[20:21], s38
  s_cmp_lg_u32 s31, 0
  s_cbranch_scc1 L_msn
  buffer_load_dwordx4 v[168:171], v45, s[8:11], s72 offen sc1
  buffer_load_dwordx4 v[172:175], v45, s[8:11], s73 offen sc1
  buffer_load_dwordx4 v[176:179], v45, s[8:11], s74 offen sc1
  buffer_load_dwordx4 v[180:183], v45, s[8:11], s75 offen sc1
  buffer_load_dwordx4 v[184:187], v45, s[8:11], s76 offen sc1
  buffer_load_dwordx4 v[188:191], v45, s[8:11], s77 offen sc1
  buffer_load_dwordx4 v[192:195], v45, s[8:11], s78 offen sc1
  buffer_load_dwordx4 v[196:199], v45, s[8:11], s79 offen sc1
  v_and_b32 v3, 15, v0
  v_lshlrev_b32 v3, 4, v3
  v_bfe_u32 v43, v0, 4, 1
  v_lshl_or_b32 v3, v43, 3, v3
  v_lshrrev_b32 v43, 5, v0
  v_lshl_or_b32 v3, v43, 8, v3
  s_lshl_b32 s38, s30, 9
  s_add_u32 s4, s24, s38
  s_addc_u32 s5, s25, 0
  s_mov_b32 s6, 512
  s_waitcnt vmcnt(0)
  v_not_b32 v168, v168
  v_not_b32 v169, v169
  v_not_b32 v170, v170
  v_not_b32 v171, v171
  v_and_b32 v172, 1, v172
  v_and_b32 v173, 1, v173
  v_and_b32 v174, 1, v174
  v_and_b32 v175, 1, v175
  v_and_b32 v176, 1, v176
  v_and_b32 v177, 1, v177
  v_and_b32 v178, 1, v178
  v_and_b32 v179, 1, v179
  v_and_b32 v180, 1, v180
  v_and_b32 v181, 1, v181
  v_and_b32 v182, 1, v182
  v_and_b32 v183, 1, v183
  v_and_b32 v184, 1, v184
  v_and_b32 v185, 1, v185
  v_and_b32 v186, 1, v186
  v_and_b32 v187, 1, v187
  v_and_b32 v188, 1, v188
  v_and_b32 v189, 1, v189
  v_and_b32 v190, 1, v190
  v_and_b32 v191, 1, v191
  v_and_b32 v192, 1, v192
  v_and_b32 v193, 1, v193
  v_and_b32 v194, 1, v194
  v_and_b32 v195, 1, v195
  v_and_b32 v196, 1, v196
  v_and_b32 v197, 1, v197
  v_and_b32 v198, 1, v198
  v_and_b32 v199, 1, v199
L_msn:
  s_mov_b32 s84, 0x6c5c40
  s_mov_b32 s85, 0x0
  s_mov_b32 s86, 0x4b4b2d
  s_mov_b32 s87, 0x0
  s_cmp_eq_u32 s31, 0
  s_cselect_b32 s82, 0, 0
  s_cselect_b32 s81, 4, 4
  s_getreg_b32 s36, hwreg(HW_REG_HW_ID, 8, 4)
  s_getreg_b32 s35, hwreg(HW_REG_HW_ID, 13, 1)
  s_sub_u32 s36, s36, s35
  s_and_b32 s36, s36, 1
  s_lshl_b32 s36, s36, 6
  s_add_u32 s35, s36, 0x80000
  s_add_u32 s12, s28, s35
  s_addc_u32 s13, s29, 0
  s_lshl_b32 s38, s30, 6
  s_add_u32 s38, s38, s31
  s_lshl2_add_u32 s38, s38, 0xa0000
  v_and_b32 v36, 7, v0
  v_lshl_add_u32 v36, v36, 2, s38
  v_mov_b32 v2, 106496
  s_getreg_b32 s38, hwreg(HW_REG_XCC_ID, 0, 3)
  s_lshl_b32 s38, s38, 15
  s_add_u32 s38, s38, 0xc0000
  v_and_b32 v51, 31, v0
  v_lshl_add_u32 v51, v51, 2, s38
  v_lshrrev_b32 v43, 5, v0
  v_lshl_add_u32 v51, v43, 11, v51
  s_lshr_b32 s39, s2, 3
  s_lshl2_add_u32 s38, s39, s38
  v_and_b32 v43, 1, v0
  v_lshl_add_u32 v49, v43, 11, s38
  s_mov_b32 s34, 16
  s_and_b32 s45, s2, 7
  s_lshl_b32 s45, s45, 12
  s_andn2_b32 s39, s39, 0x16
  s_cmp_eq_u32 s31, 0
  s_cselect_b32 s18, 0x550054, 1
  s_cselect_b32 s17, 0, 0x8000
  s_lshl_b32 s18, s18, s39
  s_and_b32 s16, s17, 0x8000
  s_or_b32 s16, s16, 0x7000
  s_or_b32 s17, s17, s45
  v_mov_b32 v56, s45
  s_mov_b64 exec, 3
  global_store_dword v49, v56, s[28:29]
  s_mov_b64 exec, -1
  s_sub_u32 s41, s2, 8
  s_and_b32 s38, s41, 7
  s_lshl_b32 s39, s38, 8
  s_add_u32 s39, s39, 0x80000
  v_bfe_u32 v38, v0, 1, 3
  v_lshl_add_u32 v47, v38, 11, s39
  v_lshl_add_u32 v47, v43, 6, v47
  v_mov_b32 v48, -1
  v_mov_b32 v57, 1
  s_cmp_ge_u32 s41, 8
  s_cbranch_scc1 L_nob
  s_mul_i32 s38, s38, 2
  s_add_i32 s38, s38, -9
  v_lshlrev_b32 v38, 3, v38
  v_lshrrev_b64 v[52:53], v38, s[84:85]
  v_and_b32 v38, 0xff, v52
  v_cmp_ne_u32 vcc, 0, v38
  s_nop 1
  s_and_b64 exec, vcc, 0xffff
  v_lshl_add_u32 v48, v38, 1, s38
  global_store_dword v47, v46, s[28:29] sc1
  s_mov_b64 exec, -1
  s_waitcnt vmcnt(0)
L_nob:
  s_mov_b32 s46, 0
  s_mov_b32 s19, 0
  s_branch L_pb8
L_back:
L_ml:
  s_add_u32 s46, s46, 1
  v_cmp_eq_u32 s[70:71], s34, v48
  s_sub_i32 s47, s34, s82
L_mw0:
  ds_read_b32 v43, v41
  s_waitcnt lgkmcnt(0)
  v_readfirstlane_b32 s37, v43
  s_cmp_ge_i32 s37, s47
  s_cbranch_scc0 L_mw0
  s_add_i32 s37, s37, s82
  global_load_dword v38, v51, s[28:29] nt
  s_mov_b32 s15, s37
  s_add_u32 s38, s37, s45
  s_add_u32 s34, s34, 1
  v_mov_b32 v56, s38
  s_mov_b64 exec, 3
  global_store_dword v49, v56, s[28:29]
  s_and_b64 exec, s[70:71], -1
  s_cbranch_scc0 L_nb0
  global_store_dword v47, v57, s[28:29] sc1
L_nb0:
  s_mov_b64 exec, -1
  s_and_b32 s38, s84, 0xff
  s_lshl1_add_u32 s38, s38, 1
  s_cmp_lg_u32 s38, s34
  s_cbranch_scc1 L_mng
  s_load_dword s48, s[12:13], 0
  s_load_dword s49, s[12:13], 256
  s_load_dword s50, s[12:13], 512
  s_load_dword s51, s[12:13], 768
  s_load_dword s52, s[12:13], 1024
  s_load_dword s53, s[12:13], 1280
  s_load_dword s54, s[12:13], 1536
  s_load_dword s55, s[12:13], 1792
  s_add_u32 s12, s12, 2048
  s_addc_u32 s13, s13, 0
  s_and_b32 s39, s86, 0xff
  s_lshr_b64 s[84:85], s[84:85], 8
  s_lshr_b64 s[86:87], s[86:87], 8
  s_mov_b32 s38, 0
  s_waitcnt lgkmcnt(0)
  s_cmp_eq_u32 s48, 1
  s_addc_u32 s38, s38, 0
  s_cmp_eq_u32 s49, 1
  s_addc_u32 s38, s38, 0
  s_cmp_eq_u32 s50, 1
  s_addc_u32 s38, s38, 0
  s_cmp_eq_u32 s51, 1
  s_addc_u32 s38, s38, 0
  s_cmp_eq_u32 s52, 1
  s_addc_u32 s38, s38, 0
  s_cmp_eq_u32 s53, 1
  s_addc_u32 s38, s38, 0
  s_cmp_eq_u32 s54, 1
  s_addc_u32 s38, s38, 0
  s_cmp_eq_u32 s55, 1
  s_addc_u32 s38, s38, 0
  s_lshl_b32 s38, s38, 2
  s_sub_i32 s38, s38, 18
  s_mul_i32 s38, s38, s39
  s_ashr_i32 s38, s38, 2
  s_pack_ll_b32_b16 s45, s45, s38
L_mng:
  v_cmp_eq_u32 s[70:71], s34, v48
  s_sub_i32 s47, s34, s82
L_mw1:
  ds_read_b32 v43, v41
  s_waitcnt lgkmcnt(0)
  v_readfirstlane_b32 s37, v43
  s_cmp_ge_i32 s37, s47
  s_cbranch_scc0 L_mw1
  s_add_i32 s37, s37, s82
  s_add_u32 s38, s37, s45
  s_add_u32 s34, s34, 1
  v_mov_b32 v56, s38
  s_mov_b64 exec, 3
  global_store_dword v49, v56, s[28:29]
  s_and_b64 exec, s[70:71], -1
  s_cbranch_scc0 L_nb1
  global_store_dword v47, v57, s[28:29] sc1
L_nb1:
  s_mov_b64 exec, -1
  v_cmp_eq_u32 s[70:71], s34, v48
  s_sub_i32 s47, s34, s82
L_mw2:
  ds_read_b32 v43, v41
  s_waitcnt lgkmcnt(0)
  v_readfirstlane_b32 s37, v43
  s_cmp_ge_i32 s37, s47
  s_cbranch_scc0 L_mw2
  s_add_i32 s37, s37, s82
  s_add_u32 s38, s37, s45
  s_add_u32 s34, s34, 1
  v_mov_b32 v56, s38
  s_mov_b64 exec, 3
  global_store_dword v49, v56, s[28:29]
  s_and_b64 exec, s[70:71], -1
  s_cbranch_scc0 L_nb2
  global_store_dword v47, v57, s[28:29] sc1
L_nb2:
  s_mov_b64 exec, -1
  s_cmp_le_u32 s46, 1
  s_waitcnt vmcnt(3)
  v_cmp_ne_u32 vcc, v38, v40
  v_mov_b32 v40, v38
  s_cbranch_scc1 L_mn
  v_and_b32 v39, s16, v38
  v_cmp_eq_u32 s[40:41], s17, v39
  v_and_b32 v38, 0xffff07ff, v38
  s_nop 1
  v_add_u32_dpp v38, v38, v38 row_shr:1 row_mask:0xf bank_mask:0xf bound_ctrl:0
  s_nop 1
  v_add_u32_dpp v38, v38, v38 row_shr:2 row_mask:0xf bank_mask:0xf bound_ctrl:0
  s_nop 1
  v_add_u32_dpp v38, v38, v38 row_shr:4 row_mask:0xf bank_mask:0xf bound_ctrl:0
  s_nop 1
  v_add_u32_dpp v38, v38, v38 row_shr:8 row_mask:0xf bank_mask:0xf bound_ctrl:0
  s_nop 1
  s_and_b32 s38, vcc_lo, s40
  s_andn2_b32 s38, s18, s38
  s_cselect_b32 s38, 0, 0x8000
  s_or_b32 s45, s45, s38
  v_readlane_b32 s38, v38, 15
  v_readlane_b32 s39, v38, 31
  v_readlane_b32 s40, v38, 47
  v_readlane_b32 s41, v38, 63
  s_add_i32 s38, s38, s39
  s_add_i32 s40, s40, s41
  s_add_i32 s38, s38, s40
  s_ashr_i32 s40, s38, 22
  s_bfe_u32 s38, s38, 0xf0001
  s_lshl_b32 s39, s15, 5
  s_sub_i32 s38, s38, s39
  s_add_i32 s38, s38, 18
  s_lshl1_add_u32 s39, s38, 1
  s_mul_i32 s39, s39, 2
  s_add_i32 s19, s19, s39
  s_max_i32 s19, s19, -5120
  s_min_i32 s19, s19, 5120
  s_mul_i32 s38, s38, 48
  s_lshl1_add_u32 s38, s38, s19
  s_ashr_i32 s38, s38, 5
  s_add_i32 s38, s38, s40
  v_mov_b32 v43, s38
  v_mov_b32 v39, s45
  ds_write2st64_b32 v41, v43, v39 offset0:3 offset1:4
L_mn:
  v_cmp_eq_u32 s[70:71], s34, v48
  s_sub_i32 s47, s34, s82
L_mw3:
  ds_read_b32 v43, v41
  s_waitcnt lgkmcnt(0)
  v_readfirstlane_b32 s37, v43
  s_cmp_ge_i32 s37, s47
  s_cbranch_scc0 L_mw3
  s_add_i32 s37, s37, s82
  s_add_u32 s38, s37, s45
  s_add_u32 s34, s34, 1
  v_mov_b32 v56, s38
  s_mov_b64 exec, 3
  global_store_dword v49, v56, s[28:29]
  s_and_b64 exec, s[70:71], -1
  s_cbranch_scc0 L_nb3
  global_store_dword v47, v57, s[28:29] sc1
L_nb3:
  s_mov_b64 exec, -1
  v_cmp_eq_u32 s[70:71], s34, v48
  s_sub_i32 s47, s34, s82
L_mw4:
  ds_read_b32 v43, v41
  s_waitcnt lgkmcnt(0)
  v_readfirstlane_b32 s37, v43
  s_cmp_ge_i32 s37, s47
  s_cbranch_scc0 L_mw4
  s_add_i32 s37, s37, s82
  s_add_u32 s38, s37, s45
  s_add_u32 s34, s34, 1
  v_mov_b32 v56, s38
  s_mov_b64 exec, 3
  global_store_dword v49, v56, s[28:29]
  s_and_b64 exec, s[70:71], -1
  s_cbranch_scc0 L_nb4
  global_store_dword v47, v57, s[28:29] sc1
L_nb4:
  s_mov_b64 exec, -1
  s_cmp_ge_i32 s15, 248
  s_cbranch_scc1 L_me
  v_cmp_eq_u32 s[70:71], s34, v48
  s_sub_i32 s47, s34, s82
L_mw5:
  ds_read_b32 v43, v41
  s_waitcnt lgkmcnt(0)
  v_readfirstlane_b32 s37, v43
  s_cmp_ge_i32 s37, s47
  s_cbranch_scc0 L_mw5
  s_add_i32 s37, s37, s82
  s_add_u32 s38, s37, s45
  s_add_u32 s34, s34, 1
  v_mov_b32 v56, s38
  s_mov_b64 exec, 3
  global_store_dword v49, v56, s[28:29]
  s_and_b64 exec, s[70:71], -1
  s_cbranch_scc0 L_nb5
  global_store_dword v47, v57, s[28:29] sc1
L_nb5:
  s_mov_b64 exec, -1
  v_cmp_eq_u32 s[70:71], s34, v48
  s_sub_i32 s47, s34, s82
L_mw6:
  ds_read_b32 v43, v41
  s_waitcnt lgkmcnt(0)
  v_readfirstlane_b32 s37, v43
  s_cmp_ge_i32 s37, s47
  s_cbranch_scc0 L_mw6
  s_add_i32 s37, s37, s82
  s_add_u32 s38, s37, s45
  s_add_u32 s34, s34, 1
  v_mov_b32 v56, s38
  s_mov_b64 exec, 3
  global_store_dword v49, v56, s[28:29]
  s_and_b64 exec, s[70:71], -1
  s_cbranch_scc0 L_nb6
  global_store_dword v47, v57, s[28:29] sc1
L_nb6:
  s_mov_b64 exec, -1
  v_cmp_eq_u32 s[70:71], s34, v48
  s_sub_i32 s47, s34, s82
L_mw7:
  ds_read_b32 v43, v41
  s_waitcnt lgkmcnt(0)
  v_readfirstlane_b32 s37, v43
  s_cmp_ge_i32 s37, s47
  s_cbranch_scc0 L_mw7
  s_add_i32 s37, s37, s82
  s_add_u32 s38, s37, s45
  s_add_u32 s34, s34, 1
  v_mov_b32 v56, s38
  s_mov_b64 exec, 3
  global_store_dword v49, v56, s[28:29]
  s_and_b64 exec, s[70:71], -1
  s_cbranch_scc0 L_nb7
  global_store_dword v47, v57, s[28:29] sc1
L_nb7:
  s_mov_b64 exec, -1
  s_cmp_lg_u32 s34, 144
  s_cbranch_scc1 L_nd
  ds_read_b32 v37, v2 offset:1024
  ds_read_b32 v39, v2 offset:10240
  s_waitcnt lgkmcnt(0)
  v_add_f32 v37, v37, v39
  s_mov_b64 exec, 1
  global_store_dword v36, v37, s[28:29]
  s_mov_b64 exec, -1
  s_waitcnt vmcnt(0)
  s_bitset1_b32 s45, 11
L_nd:
  s_branch L_ml
L_pb4:
  s_branch L_pb3
L_me:
  s_cmp_lg_u32 s31, 0
  s_cbranch_scc1 L_done
  v_add_u32 v1, 106496, v45
  s_mov_b32 s47, 253
  s_mov_b32 s44, 0xff
  s_mov_b32 s39, 64
  v_mov_b32 v136, 0
  v_mov_b32 v137, 0
  v_mov_b32 v138, 0
  v_mov_b32 v139, 0
  s_bitcmp1_b32 s45, 15
  s_cbranch_scc0 L_sto
  s_bitcmp1_b32 s45, 11
  s_cbranch_scc0 L_sto
  s_and_b32 s38, s45, 0x7800
  v_and_b32 v39, 0x7800, v40
  v_cmp_eq_u32 vcc, s38, v39
  s_nop 1
  s_andn2_b32 s38, s18, vcc_lo
  s_cbranch_scc1 L_sto
  global_load_dword v38, v36, s[28:29] nt
  s_waitcnt vmcnt(0)
  s_nop 1
  v_add_f32_dpp v38, v38, v38 quad_perm:[1,0,3,2] row_mask:0xf bank_mask:0xf
  s_nop 1
  v_add_f32_dpp v38, v38, v38 quad_perm:[2,3,0,1] row_mask:0xf bank_mask:0xf
  s_nop 1
  v_add_f32_dpp v38, v38, v38 row_half_mirror row_mask:0xf bank_mask:0xf
  v_add_f32 v38, 0x358637bd, v38
  v_rcp_f32 v64, v38
  s_bitcmp1_b32 s44, 0
  v_fma_f32 v65, -v38, v64, 1.0
  v_fmac_f32 v64, v65, v64
  v_div_fixup_f32 v64, v64, v38, 1.0
L_mwc:
  ds_read_b32 v43, v41
  s_waitcnt lgkmcnt(0)
  v_readfirstlane_b32 s37, v43
  s_cmp_ge_i32 s37, s47
  s_cbranch_scc0 L_mwc
L_sw:
  buffer_load_dwordx4 v[108:111], v45, s[8:11], s73 offen nt
  buffer_load_dwordx4 v[112:115], v45, s[8:11], s74 offen nt
  buffer_load_dwordx4 v[116:119], v45, s[8:11], s75 offen nt
  buffer_load_dwordx4 v[120:123], v45, s[8:11], s76 offen nt
  buffer_load_dwordx4 v[124:127], v45, s[8:11], s77 offen nt
  buffer_load_dwordx4 v[128:131], v45, s[8:11], s78 offen nt
  buffer_load_dwordx4 v[132:135], v45, s[8:11], s79 offen nt
  s_bitcmp1_b32 s44, 0
  s_cbranch_scc0 L_swl
  ds_read2_b32 v[52:53], v41 offset0:64 offset1:128
  ds_read_b128 v[80:83], v1
  ds_read_b128 v[84:87], v1 offset:9216
  s_waitcnt lgkmcnt(0)
  v_min_i32 v43, v52, v53
  s_nop 0
  v_readfirstlane_b32 s37, v43
  s_cmp_ge_i32 s37, 1000
  s_cbranch_scc0 L_swl
  s_bitset0_b32 s44, 0
  v_pk_add_f32 v[136:137], v[80:81], v[84:85]
  v_pk_add_f32 v[138:139], v[82:83], v[86:87]
L_swl:
  s_sub_u32 s39, s39, 1
  s_cbranch_scc1 L_sto
  s_waitcnt vmcnt(6)
  v_lshl_add_u64 v[108:109], v[108:109], 0, v[172:173]
  v_lshl_add_u64 v[110:111], v[110:111], 0, v[174:175]
  v_bitop3_b32 v39, 1, v108, v109 bitop3:0x80
  v_bitop3_b32 v39, v39, v110, v111 bitop3:0x80
  s_waitcnt vmcnt(5)
  v_lshl_add_u64 v[112:113], v[112:113], 0, v[176:177]
  v_lshl_add_u64 v[114:115], v[114:115], 0, v[178:179]
  v_pk_add_f32 v[72:73], v[108:109], v[112:113]
  v_pk_add_f32 v[74:75], v[110:111], v[114:115]
  v_bitop3_b32 v39, v39, v112, v113 bitop3:0x80
  v_bitop3_b32 v39, v39, v114, v115 bitop3:0x80
  s_waitcnt vmcnt(4)
  v_lshl_add_u64 v[116:117], v[116:117], 0, v[180:181]
  v_lshl_add_u64 v[118:119], v[118:119], 0, v[182:183]
  v_pk_add_f32 v[72:73], v[72:73], v[116:117]
  v_pk_add_f32 v[74:75], v[74:75], v[118:119]
  v_bitop3_b32 v39, v39, v116, v117 bitop3:0x80
  v_bitop3_b32 v39, v39, v118, v119 bitop3:0x80
  s_waitcnt vmcnt(3)
  v_lshl_add_u64 v[120:121], v[120:121], 0, v[184:185]
  v_lshl_add_u64 v[122:123], v[122:123], 0, v[186:187]
  v_pk_add_f32 v[72:73], v[72:73], v[120:121]
  v_pk_add_f32 v[74:75], v[74:75], v[122:123]
  v_bitop3_b32 v39, v39, v120, v121 bitop3:0x80
  v_bitop3_b32 v39, v39, v122, v123 bitop3:0x80
  s_waitcnt vmcnt(2)
  v_lshl_add_u64 v[124:125], v[124:125], 0, v[188:189]
  v_lshl_add_u64 v[126:127], v[126:127], 0, v[190:191]
  v_pk_add_f32 v[72:73], v[72:73], v[124:125]
  v_pk_add_f32 v[74:75], v[74:75], v[126:127]
  v_bitop3_b32 v39, v39, v124, v125 bitop3:0x80
  v_bitop3_b32 v39, v39, v126, v127 bitop3:0x80
  s_waitcnt vmcnt(1)
  v_lshl_add_u64 v[128:129], v[128:129], 0, v[192:193]
  v_lshl_add_u64 v[130:131], v[130:131], 0, v[194:195]
  v_pk_add_f32 v[72:73], v[72:73], v[128:129]
  v_pk_add_f32 v[74:75], v[74:75], v[130:131]
  v_bitop3_b32 v39, v39, v128, v129 bitop3:0x80
  v_bitop3_b32 v39, v39, v130, v131 bitop3:0x80
  s_waitcnt vmcnt(0)
  v_lshl_add_u64 v[132:133], v[132:133], 0, v[196:197]
  v_lshl_add_u64 v[134:135], v[134:135], 0, v[198:199]
  v_pk_add_f32 v[72:73], v[72:73], v[132:133]
  v_pk_add_f32 v[74:75], v[74:75], v[134:135]
  v_bitop3_b32 v39, v39, v132, v133 bitop3:0x80
  v_bitop3_b32 v39, v39, v134, v135 bitop3:0x80
  v_cmp_eq_u32 vcc, 0, v39
  v_pk_add_f32 v[72:73], v[72:73], v[136:137]
  v_pk_add_f32 v[74:75], v[74:75], v[138:139]
  s_bitcmp1_b32 s44, 0
  v_pk_mul_f32 v[76:77], v[72:73], v[64:65] op_sel_hi:[1,0]
  v_pk_mul_f32 v[78:79], v[74:75], v[64:65] op_sel_hi:[1,0]
  v_cvt_pk_bf16_f32 v76, v76, v77
  v_cvt_pk_bf16_f32 v77, v78, v79
  s_cbranch_vccnz L_sw
  s_cbranch_scc1 L_swm
  buffer_store_dwordx2 v[76:77], v3, s[4:7], 0 offen
  s_endpgm
L_swm:
L_lwm:
  ds_read2_b32 v[52:53], v41 offset0:64 offset1:128
  ds_read_b128 v[80:83], v1
  ds_read_b128 v[84:87], v1 offset:9216
  s_waitcnt lgkmcnt(2)
  v_min_i32 v43, v52, v53
  s_nop 0
  v_readfirstlane_b32 s37, v43
  s_cmp_ge_i32 s37, 1000
  s_waitcnt lgkmcnt(0)
  s_cbranch_scc0 L_lwm
  v_pk_add_f32 v[80:81], v[80:81], v[84:85]
  v_pk_add_f32 v[82:83], v[82:83], v[86:87]
  v_pk_add_f32 v[72:73], v[72:73], v[80:81]
  v_pk_add_f32 v[74:75], v[74:75], v[82:83]
  s_bitcmp1_b32 s44, 0
  v_pk_mul_f32 v[76:77], v[72:73], v[64:65] op_sel_hi:[1,0]
  v_pk_mul_f32 v[78:79], v[74:75], v[64:65] op_sel_hi:[1,0]
  v_cvt_pk_bf16_f32 v76, v76, v77
  v_cvt_pk_bf16_f32 v77, v78, v79
  buffer_store_dwordx2 v[76:77], v3, s[4:7], 0 offen
  s_endpgm
L_sto:
L_lws:
  ds_read2_b32 v[52:53], v41 offset0:64 offset1:128
  ds_read_b32 v37, v2 offset:1024
  ds_read_b32 v38, v2 offset:10240
  ds_read_b128 v[80:83], v1
  ds_read_b128 v[84:87], v1 offset:9216
  s_waitcnt lgkmcnt(4)
  v_min_i32 v43, v52, v53
  s_nop 0
  v_readfirstlane_b32 s37, v43
  s_cmp_ge_i32 s37, 1000
  s_waitcnt lgkmcnt(0)
  s_cbranch_scc0 L_lws
  v_add_f32 v37, v37, v38
  v_pk_add_f32 v[80:81], v[80:81], v[84:85]
  v_pk_add_f32 v[82:83], v[82:83], v[86:87]
  s_mov_b32 s38, 0
  s_bitcmp1_b32 s45, 15
  s_waitcnt vmcnt(0)
  s_cbranch_scc1 L_poll
  s_branch L_put
.p2align 12
L_pa0:
  s_branch L_bar
L_consumer:
  s_lshr_b32 s30, s39, 23
  s_mov_b32 s33, 0
  v_lshlrev_b32 v45, 4, v0
  s_mov_b32 s11, 0x20000
  s_cmp_eq_u32 s32, 3
  s_cbranch_scc1 L_mon
  s_sub_u32 s46, s32, 1
  s_lshl_b32 s38, s32, 8
  v_add_u32 v42, s38, v41
  v_lshl_or_b32 v4, v1, 9, v2
  v_xor_b32 v5, 0x20, v4
  v_xor_b32 v6, 0x40, v4
  v_xor_b32 v7, 0x60, v4
  v_xor_b32 v8, 0x1080, v4
  v_xor_b32 v9, 0x10a0, v4
  v_xor_b32 v10, 0x10c0, v4
  v_xor_b32 v11, 0x10e0, v4
  s_mul_i32 s40, s46, 9216
  s_add_u32 s40, s40, 106496
  s_mov_b32 s10, 8192
  s_waitcnt lgkmcnt(0)
  s_mov_b32 s8, s22
  s_mov_b32 s9, s23
  s_add_u32 m0, s40, 0
  s_nop 0
  buffer_load_dwordx4 v4, s[8:11], 0 offen offset:0 lds
  buffer_load_dwordx4 v5, s[8:11], 0 offen offset:1024 lds
  buffer_load_dwordx4 v6, s[8:11], 0 offen offset:2048 lds
  buffer_load_dwordx4 v7, s[8:11], 0 offen offset:3072 lds
  s_add_u32 m0, s40, 4096
  s_nop 0
  buffer_load_dwordx4 v8, s[8:11], 0 offen offset:0 lds
  buffer_load_dwordx4 v9, s[8:11], 0 offen offset:1024 lds
  buffer_load_dwordx4 v10, s[8:11], 0 offen offset:2048 lds
  buffer_load_dwordx4 v11, s[8:11], 0 offen offset:3072 lds
  s_lshl_b32 s38, s30, 9
  s_add_u32 s8, s16, s38
  s_addc_u32 s9, s17, 0
  s_mov_b32 s10, 512
  s_add_u32 m0, s40, 8192
  s_nop 0
  buffer_load_dwordx4 v45, s[8:11], 0 offen lds
  s_bfe_u32 s31, s2, 0x20004
  s_bfe_u32 s38, s2, 0x10007
  s_lshl_b32 s38, s38, 2
  s_or_b32 s31, s31, s38
  s_lshl_b32 s38, s30, 13
  s_add_u32 s8, s28, s38
  s_addc_u32 s9, s29, 0
  s_mov_b32 s10, 8192
  s_lshl_b32 s38, s30, 3
  s_add_u32 s56, s26, s38
  s_addc_u32 s57, s27, 0
  s_add_u32 s38, s31, 0
  s_and_b32 s38, s38, 7
  s_lshl_b32 s72, s38, 10
  s_add_u32 s38, s31, 1
  s_and_b32 s38, s38, 7
  s_lshl_b32 s73, s38, 10
  s_add_u32 s38, s31, 2
  s_and_b32 s38, s38, 7
  s_lshl_b32 s74, s38, 10
  s_add_u32 s38, s31, 3
  s_and_b32 s38, s38, 7
  s_lshl_b32 s75, s38, 10
  s_add_u32 s38, s31, 4
  s_and_b32 s38, s38, 7
  s_lshl_b32 s76, s38, 10
  s_add_u32 s38, s31, 5
  s_and_b32 s38, s38, 7
  s_lshl_b32 s77, s38, 10
  s_add_u32 s38, s31, 6
  s_and_b32 s38, s38, 7
  s_lshl_b32 s78, s38, 10
  s_add_u32 s38, s31, 7
  s_and_b32 s38, s38, 7
  s_lshl_b32 s79, s38, 10
  s_cmp_lg_u32 s31, 0
  s_cselect_b32 s59, s46, 0
  s_cmp_eq_u32 s59, 0
  s_cbranch_scc1 L_nosnap
  buffer_load_dwordx4 v[168:171], v45, s[8:11], s72 offen sc1
L_nosnap:
  v_lshrrev_b32 v1, 4, v0
  v_and_b32 v2, 15, v0
  v_xor_b32 v3, v1, v2
  v_lshlrev_b32 v3, 4, v3
  v_lshl_or_b32 v12, v2, 9, v3
  v_xor_b32 v13, 0x40, v12
  v_xor_b32 v14, 0x80, v12
  v_xor_b32 v15, 0xc0, v12
  v_lshl_or_b32 v16, v1, 9, v3
  v_xor_b32 v17, 0x840, v16
  v_xor_b32 v18, 0x1080, v16
  v_xor_b32 v19, 0x18c0, v16
  s_lshl_b32 s38, s46, 6
  s_add_u32 s38, s38, 98304
  v_and_b32 v24, 3, v2
  v_lshlrev_b32 v24, 4, v24
  v_and_b32 v25, 12, v2
  v_add3_u32 v24, v24, v25, s38
  v_lshl_add_u32 v25, v1, 4, s38
  v_cmp_le_u32 vcc, 8, v2
  v_mov_b32 v3, 0xffff0000
  v_mov_b32 v31, 1.0
  v_cndmask_b32 v26, 0, v3, vcc
  v_and_b32 v38, 1, v2
  v_cmp_eq_u32 vcc, 1, v38
  v_mov_b32 v39, 0x0c0c0302
  v_mov_b32 v40, 0x03020c0c
  v_cndmask_b32 v39, v39, v40, vcc
  v_bfe_u32 v38, v2, 1, 2
  v_mov_b32 v40, 0x0c0c0c0c
  v_cmp_eq_u32 vcc, 0, v38
  s_nop 1
  v_cndmask_b32 v27, v40, v39, vcc
  v_cmp_eq_u32 vcc, 1, v38
  s_nop 1
  v_cndmask_b32 v28, v40, v39, vcc
  v_cmp_eq_u32 vcc, 2, v38
  s_nop 1
  v_cndmask_b32 v29, v40, v39, vcc
  v_cmp_eq_u32 vcc, 3, v38
  s_nop 1
  v_cndmask_b32 v30, v40, v39, vcc
  s_mov_b32 s48, 0x100001
  s_mov_b32 s49, 0x10000100
  s_mov_b32 s50, 0x200002
  s_mov_b32 s51, 0x20000200
  s_mov_b32 s52, 0x400004
  s_mov_b32 s53, 0x40000400
  s_mov_b32 s54, 0x800008
  s_mov_b32 s55, 0x80000800
  s_mov_b32 s44, 0xbe000000
  v_mov_b32 v80, 0
  v_mov_b32 v81, 0
  v_mov_b32 v82, 0
  v_mov_b32 v83, 0
  v_mov_b32 v84, 0
  v_mov_b32 v85, 0
  v_mov_b32 v86, 0
  v_mov_b32 v87, 0
  v_mov_b32 v37, 0
  v_mov_b32 v52, 0
  v_add_u32 v20, s40, v12
  v_add_u32 v21, s40, v13
  v_add_u32 v22, s40, v14
  v_add_u32 v23, s40, v15
  v_lshl_add_u32 v1, v1, 4, s40
  s_lshl_b32 s34, s46, 13
  s_add_u32 s45, s34, 98304
  s_mov_b32 s41, s34
  s_mov_b32 s47, s46
  s_mov_b32 s37, 0
  s_cmp_eq_u32 s59, 0
  s_cbranch_scc1 L_w0
  s_waitcnt vmcnt(1)
  s_branch L_w1
L_pa1:
  s_branch L_bar
L_w0:
  s_waitcnt vmcnt(0)
L_w1:
  ds_read_b128 v[104:107], v20 offset:0
  ds_read_b128 v[108:111], v21 offset:0
  ds_read_b128 v[112:115], v22 offset:0
  ds_read_b128 v[116:119], v23 offset:0
  ds_read_b128 v[120:123], v20 offset:256
  ds_read_b128 v[124:127], v21 offset:256
  ds_read_b128 v[128:131], v22 offset:256
  ds_read_b128 v[132:135], v23 offset:256
  ds_read_b128 v[136:139], v1 offset:8192
  ds_read_b128 v[140:143], v1 offset:8256
  ds_read_b128 v[144:147], v1 offset:8320
  ds_read_b128 v[148:151], v1 offset:8384
  ds_read_b128 v[152:155], v1 offset:8448
  ds_read_b128 v[156:159], v1 offset:8512
  ds_read_b128 v[160:163], v1 offset:8576
  ds_read_b128 v[164:167], v1 offset:8640
  s_waitcnt lgkmcnt(0)
  v_mfma_f32_16x16x32_bf16 v[68:71], v[136:139], v[136:139], 0
  v_mfma_f32_16x16x32_bf16 v[68:71], v[140:143], v[140:143], v[68:71]
  v_mfma_f32_16x16x32_bf16 v[68:71], v[144:147], v[144:147], v[68:71]
  v_mfma_f32_16x16x32_bf16 v[68:71], v[148:151], v[148:151], v[68:71]
  v_mfma_f32_16x16x32_bf16 v[68:71], v[152:155], v[152:155], v[68:71]
  v_mfma_f32_16x16x32_bf16 v[68:71], v[156:159], v[156:159], v[68:71]
  v_mfma_f32_16x16x32_bf16 v[68:71], v[160:163], v[160:163], v[68:71]
  v_mfma_f32_16x16x32_bf16 v[68:71], v[164:167], v[164:167], v[68:71]
  v_mfma_f32_16x16x32_bf16 v[64:67], v[104:107], v[136:139], 0
  v_mfma_f32_16x16x32_bf16 v[64:67], v[108:111], v[140:143], v[64:67]
  v_mfma_f32_16x16x32_bf16 v[64:67], v[112:115], v[144:147], v[64:67]
  v_mfma_f32_16x16x32_bf16 v[64:67], v[116:119], v[148:151], v[64:67]
  v_mfma_f32_16x16x32_bf16 v[64:67], v[120:123], v[152:155], v[64:67]
  v_mfma_f32_16x16x32_bf16 v[64:67], v[124:127], v[156:159], v[64:67]
  v_mfma_f32_16x16x32_bf16 v[64:67], v[128:131], v[160:163], v[64:67]
  v_mfma_f32_16x16x32_bf16 v[64:67], v[132:135], v[164:167], v[64:67]
  v_cvt_pk_bf16_f32 v40, 0, v68
  s_nop 7
  v_cvt_pk_bf16_f32 v64, 0, v64
  v_cvt_pk_bf16_f32 v65, 0, v65
  v_cvt_pk_bf16_f32 v66, 0, v66
  v_cvt_pk_bf16_f32 v67, 0, v67
  v_fmac_f32 v64, s44, v40
  v_fmac_f32 v65, s44, v40
  v_fmac_f32 v66, s44, v40
  v_fmac_f32 v67, s44, v40
  v_cvt_pk_bf16_f32 v64, 0, v64
  v_cvt_pk_bf16_f32 v65, 0, v65
  v_cvt_pk_bf16_f32 v66, 0, v66
  v_cvt_pk_bf16_f32 v67, 0, v67
  v_mul_f32 v64, 0x3eb8aa3b, v64
  v_mul_f32 v65, 0x3eb8aa3b, v65
  v_mul_f32 v66, 0x3eb8aa3b, v66
  v_mul_f32 v67, 0x3eb8aa3b, v67
  v_exp_f32 v64, v64
  v_exp_f32 v65, v65
  v_exp_f32 v66, v66
  v_exp_f32 v67, v67
  v_mov_b32 v1, 0x358637bd
  v_cvt_pk_bf16_f32 v64, 0, v64
  v_cvt_pk_bf16_f32 v65, 0, v65
  v_cvt_pk_bf16_f32 v66, 0, v66
  v_cvt_pk_bf16_f32 v67, 0, v67
  v_fmamk_f32 v64, v64, 0x3e800000, v1
  v_fmamk_f32 v65, v65, 0x3e800000, v1
  v_fmamk_f32 v66, v66, 0x3e800000, v1
  v_fmamk_f32 v67, v67, 0x3e800000, v1
  v_cvt_pk_bf16_f32 v64, 0, v64
  v_cvt_pk_bf16_f32 v65, 0, v65
  v_cvt_pk_bf16_f32 v66, 0, v66
  v_cvt_pk_bf16_f32 v67, 0, v67
  v_add_f32 v36, v64, v65
  v_add_f32 v38, v66, v67
  v_add_f32 v36, v36, v38
  v_mul_f32 v36, v36, v1
  v_mul_f32 v32, 0x3e800000, v64
  v_mul_f32 v33, 0x3e800000, v65
  v_mul_f32 v34, 0x3e800000, v66
  v_mul_f32 v35, 0x3e800000, v67
L_kbody:
  v_add_u32 v20, s34, v12
  v_add_u32 v21, s34, v13
  v_add_u32 v22, s34, v14
  v_add_u32 v23, s34, v15
  v_add_u32 v52, 1, v52
L_wfk:
  s_cmp_gt_i32 s37, s47
  s_cbranch_scc1 L_gok
  ds_read_b32 v43, v41
  s_waitcnt lgkmcnt(0)
  v_readfirstlane_b32 s37, v43
  s_branch L_wfk
L_pb5:
  s_branch L_pb4
L_gok:
  ds_read_b128 v[136:139], v20 offset:0
  ds_read_b128 v[140:143], v21 offset:0
  ds_read_b128 v[144:147], v22 offset:0
  ds_read_b128 v[148:151], v23 offset:0
  ds_read_b128 v[152:155], v20 offset:256
  ds_read_b128 v[156:159], v21 offset:256
  ds_read_b128 v[160:163], v22 offset:256
  ds_read_b128 v[164:167], v23 offset:256
  s_waitcnt lgkmcnt(7)
  v_mfma_f32_16x16x32_bf16 v[68:71], v[136:139], v[136:139], 0
  s_waitcnt lgkmcnt(6)
  v_mfma_f32_16x16x32_bf16 v[68:71], v[140:143], v[140:143], v[68:71]
  s_waitcnt lgkmcnt(5)
  v_mfma_f32_16x16x32_bf16 v[68:71], v[144:147], v[144:147], v[68:71]
  s_waitcnt lgkmcnt(4)
  v_mfma_f32_16x16x32_bf16 v[68:71], v[148:151], v[148:151], v[68:71]
  s_waitcnt lgkmcnt(3)
  v_mfma_f32_16x16x32_bf16 v[68:71], v[152:155], v[152:155], v[68:71]
  s_waitcnt lgkmcnt(2)
  v_mfma_f32_16x16x32_bf16 v[68:71], v[156:159], v[156:159], v[68:71]
  s_waitcnt lgkmcnt(1)
  v_mfma_f32_16x16x32_bf16 v[68:71], v[160:163], v[160:163], v[68:71]
  s_waitcnt lgkmcnt(0)
  v_mfma_f32_16x16x32_bf16 v[68:71], v[164:167], v[164:167], v[68:71]
  ds_write_b32 v42, v52
  v_mfma_f32_16x16x32_bf16 v[64:67], v[104:107], v[136:139], 0
  v_mfma_f32_16x16x32_bf16 v[64:67], v[108:111], v[140:143], v[64:67]
  v_mfma_f32_16x16x32_bf16 v[64:67], v[112:115], v[144:147], v[64:67]
  v_mfma_f32_16x16x32_bf16 v[64:67], v[116:119], v[148:151], v[64:67]
  v_mfma_f32_16x16x32_bf16 v[64:67], v[120:123], v[152:155], v[64:67]
  v_mfma_f32_16x16x32_bf16 v[64:67], v[124:127], v[156:159], v[64:67]
  v_mfma_f32_16x16x32_bf16 v[64:67], v[128:131], v[160:163], v[64:67]
  v_mfma_f32_16x16x32_bf16 v[64:67], v[132:135], v[164:167], v[64:67]
  v_cndmask_b32 v38, 0, v68, s[48:49]
  v_cndmask_b32 v38, v38, v69, s[50:51]
  v_cndmask_b32 v38, v38, v70, s[52:53]
  v_cndmask_b32 v38, v38, v71, s[54:55]
  s_nop 1
  v_mfma_f32_16x16x4_f32 v[72:75], v31, v38, 0
  s_nop 1
  v_cvt_pk_bf16_f32 v64, 0, v64
  v_cvt_pk_bf16_f32 v65, 0, v65
  v_cvt_pk_bf16_f32 v66, 0, v66
  v_cvt_pk_bf16_f32 v67, 0, v67
  s_nop 3
  v_cvt_pk_bf16_f32 v40, 0, v72
  v_fmac_f32 v64, s44, v40
  v_fmac_f32 v65, s44, v40
  v_fmac_f32 v66, s44, v40
  v_fmac_f32 v67, s44, v40
  v_cvt_pk_bf16_f32 v64, 0, v64
  v_cvt_pk_bf16_f32 v65, 0, v65
  v_cvt_pk_bf16_f32 v66, 0, v66
  v_cvt_pk_bf16_f32 v67, 0, v67
  v_mul_f32 v64, 0x3eb8aa3b, v64
  v_mul_f32 v65, 0x3eb8aa3b, v65
  v_mul_f32 v66, 0x3eb8aa3b, v66
  v_mul_f32 v67, 0x3eb8aa3b, v67
  v_exp_f32 v64, v64
  v_exp_f32 v65, v65
  v_exp_f32 v66, v66
  v_exp_f32 v67, v67
  v_fma_f32 v39, v32, v64, v36
  v_fmac_f32 v39, v33, v65
  v_fmac_f32 v39, v34, v66
  v_fmac_f32 v39, v35, v67
  s_nop 1
  v_mfma_f32_16x16x4_f32 v[76:79], v31, v39, 0
  v_add_f32 v37, v37, v39
  s_add_u32 s34, s34, 16384
  s_cmp_eq_u32 s34, s45
  s_cselect_b32 s34, s41, s34
  s_add_u32 s33, s33, 1
  s_add_u32 s47, s47, 2
  s_nop 4
  ds_write_b32 v24, v76
  v_add_u32 v24, 128, v24
  s_cmp_lt_u32 s33, 64
  s_cbranch_scc1 L_kbody
  v_mfma_f32_16x16x4_f32 v[64:67], v37, v31, 0
  v_mov_b32 v38, s40
  s_nop 7
  s_nop 0
  v_add_f32 v64, v64, v65
  v_add_f32 v66, v66, v67
  v_add_f32 v64, v64, v66
  s_nop 1
  v_mfma_f32_16x16x4_f32 v[68:71], v31, v64, 0
  v_add_u32 v1, s40, v45
  v_mov_b32 v2, 1000
  s_cmp_eq_u32 s59, 0
  s_cbranch_scc1 L_nock
  s_waitcnt vmcnt(0)
  v_not_b32 v168, v168
  v_not_b32 v169, v169
  v_not_b32 v170, v170
  v_not_b32 v171, v171
  v_add_u32 v1, 106496, v45
  v_mov_b32 v2, 106496
  v_and_b32 v3, 15, v0
  v_lshlrev_b32 v3, 4, v3
  v_bfe_u32 v43, v0, 4, 1
  v_lshl_or_b32 v3, v43, 3, v3
  v_lshrrev_b32 v43, 5, v0
  v_lshl_or_b32 v3, v43, 8, v3
  s_lshl_b32 s38, s30, 9
  s_add_u32 s4, s24, s38
  s_addc_u32 s5, s25, 0
  s_mov_b32 s6, 512
L_nock:
  s_nop 7
  v_mov_b32 v37, v68
  ds_write_b32 v38, v68 offset:1024
  s_cmp_eq_u32 s46, 0
  s_cselect_b32 s80, 0, 0xce000
  s_cselect_b32 s88, 11, 19
  s_xor_b32 s80, s80, s36
  s_xor_b32 s80, s80, 0x35b800
  s_lshl_b32 s38, s30, 23
  s_add_u32 s84, s20, s38
  s_addc_u32 s85, s21, 0
  s_mov_b32 s86, 0x800000
  s_mov_b32 s87, 0x20000
  v_and_b32 v4, 15, v0
  v_lshl_or_b32 v4, v4, 4, s80
  v_bfe_u32 v5, v0, 4, 1
  v_mul_u32_u24 v5, 0x42400, v5
  v_xor_b32 v4, v4, v5
  v_bfe_u32 v5, v0, 5, 1
  v_mul_u32_u24 v5, 0x482200, v5
  v_xor_b32 v4, v4, v5
  v_xor_b32 v5, 0x8000, v4
  v_xor_b32 v6, 0x280200, v4
  v_xor_b32 v7, 0x288200, v4
L_vbody:
  ds_read_b128 v[76:79], v25
  v_add_u32 v25, 128, v25
  v_add_u32 v20, s34, v16
  v_add_u32 v21, s34, v17
  v_add_u32 v22, s34, v18
  v_add_u32 v23, s34, v19
  v_add_u32 v52, 1, v52
  s_waitcnt lgkmcnt(0)
  v_and_b32 v72, v76, v26
  v_and_b32 v73, v77, v26
  v_and_b32 v74, v78, v26
  v_and_b32 v75, v79, v26
  v_sub_f32 v76, v76, v72
  v_sub_f32 v77, v77, v73
  v_sub_f32 v78, v78, v74
  v_sub_f32 v79, v79, v75
  v_perm_b32 v88, v76, v76, v27
  v_perm_b32 v89, v76, v76, v28
  v_perm_b32 v90, v76, v76, v29
  v_perm_b32 v91, v76, v76, v30
  v_perm_b32 v92, v77, v77, v27
  v_perm_b32 v93, v77, v77, v28
  v_perm_b32 v94, v77, v77, v29
  v_perm_b32 v95, v77, v77, v30
  v_perm_b32 v96, v78, v78, v27
  v_perm_b32 v97, v78, v78, v28
  v_perm_b32 v98, v78, v78, v29
  v_perm_b32 v99, v78, v78, v30
  v_perm_b32 v100, v79, v79, v27
  v_perm_b32 v101, v79, v79, v28
  v_perm_b32 v102, v79, v79, v29
  v_perm_b32 v103, v79, v79, v30
L_wfv:
  s_cmp_gt_i32 s37, s47
  s_cbranch_scc1 L_gov
  ds_read_b32 v43, v41
  s_waitcnt lgkmcnt(0)
  v_readfirstlane_b32 s37, v43
  s_branch L_wfv
L_pb6:
  s_branch L_pb5
L_gov:
  ds_read_b128 v[136:139], v20 offset:0
  ds_read_b128 v[140:143], v20 offset:256
  ds_read_b128 v[144:147], v21 offset:0
  ds_read_b128 v[148:151], v21 offset:256
  ds_read_b128 v[152:155], v22 offset:0
  ds_read_b128 v[156:159], v22 offset:256
  ds_read_b128 v[160:163], v23 offset:0
  ds_read_b128 v[164:167], v23 offset:256
  s_waitcnt lgkmcnt(7)
  v_mfma_f32_16x16x32_bf16 v[80:83], v[88:91], v[136:139], v[80:83]
  s_waitcnt lgkmcnt(6)
  v_mfma_f32_16x16x32_bf16 v[84:87], v[88:91], v[140:143], v[84:87]
  s_waitcnt lgkmcnt(5)
  v_mfma_f32_16x16x32_bf16 v[80:83], v[92:95], v[144:147], v[80:83]
  s_waitcnt lgkmcnt(4)
  v_mfma_f32_16x16x32_bf16 v[84:87], v[92:95], v[148:151], v[84:87]
  s_waitcnt lgkmcnt(3)
  v_mfma_f32_16x16x32_bf16 v[80:83], v[96:99], v[152:155], v[80:83]
  s_waitcnt lgkmcnt(2)
  v_mfma_f32_16x16x32_bf16 v[84:87], v[96:99], v[156:159], v[84:87]
  s_waitcnt lgkmcnt(1)
  v_mfma_f32_16x16x32_bf16 v[80:83], v[100:103], v[160:163], v[80:83]
  s_waitcnt lgkmcnt(0)
  v_mfma_f32_16x16x32_bf16 v[84:87], v[100:103], v[164:167], v[84:87]
  ds_write_b32 v42, v52
  s_add_u32 s34, s34, 16384
  s_cmp_eq_u32 s34, s45
  s_cselect_b32 s34, s41, s34
  s_add_u32 s33, s33, 1
  s_add_u32 s47, s47, 2
  s_cmp_lt_u32 s33, 126
  s_cbranch_scc1 L_vbody
L_dw:
  ds_read2st64_b32 v[64:65], v41 offset0:3 offset1:5
  s_waitcnt lgkmcnt(0)
  v_readfirstlane_b32 s38, v64
  v_readfirstlane_b32 s39, v65
  s_mul_i32 s38, s38, 12
  s_ashr_i32 s38, s38, 8
  s_max_i32 s38, s38, -8
  s_add_i32 s38, s38, s39
  s_cmp_ge_i32 s38, s88
  s_cbranch_scc0 L_dw
  buffer_load_dwordx4 v[104:107], v4, s[84:87], 0 offen offset:0 nt
  buffer_load_dwordx4 v[108:111], v4, s[84:87], 0 offen offset:256 nt
  buffer_load_dwordx4 v[112:115], v5, s[84:87], 0 offen offset:0 nt
  buffer_load_dwordx4 v[116:119], v5, s[84:87], 0 offen offset:256 nt
  buffer_load_dwordx4 v[120:123], v6, s[84:87], 0 offen offset:0 nt
  buffer_load_dwordx4 v[124:127], v6, s[84:87], 0 offen offset:256 nt
  buffer_load_dwordx4 v[128:131], v7, s[84:87], 0 offen offset:0 nt
  buffer_load_dwordx4 v[132:135], v7, s[84:87], 0 offen offset:256 nt
  ds_read_b128 v[76:79], v25
  v_add_u32 v25, 128, v25
  v_add_u32 v20, s34, v16
  v_add_u32 v21, s34, v17
  v_add_u32 v22, s34, v18
  v_add_u32 v23, s34, v19
  v_add_u32 v52, 1, v52
  s_waitcnt lgkmcnt(0)
  v_and_b32 v72, v76, v26
  v_and_b32 v73, v77, v26
  v_and_b32 v74, v78, v26
  v_and_b32 v75, v79, v26
  v_sub_f32 v76, v76, v72
  v_sub_f32 v77, v77, v73
  v_sub_f32 v78, v78, v74
  v_sub_f32 v79, v79, v75
  v_perm_b32 v88, v76, v76, v27
  v_perm_b32 v89, v76, v76, v28
  v_perm_b32 v90, v76, v76, v29
  v_perm_b32 v91, v76, v76, v30
  v_perm_b32 v92, v77, v77, v27
  v_perm_b32 v93, v77, v77, v28
  v_perm_b32 v94, v77, v77, v29
  v_perm_b32 v95, v77, v77, v30
  v_perm_b32 v96, v78, v78, v27
  v_perm_b32 v97, v78, v78, v28
  v_perm_b32 v98, v78, v78, v29
  v_perm_b32 v99, v78, v78, v30
  v_perm_b32 v100, v79, v79, v27
  v_perm_b32 v101, v79, v79, v28
  v_perm_b32 v102, v79, v79, v29
  v_perm_b32 v103, v79, v79, v30
L_wfw:
  s_cmp_gt_i32 s37, s47
  s_cbranch_scc1 L_gow
  ds_read_b32 v43, v41
  s_waitcnt lgkmcnt(0)
  v_readfirstlane_b32 s37, v43
  s_branch L_wfw
L_pb7:
  s_branch L_pb6
L_gow:
  ds_read_b128 v[136:139], v20 offset:0
  ds_read_b128 v[140:143], v20 offset:256
  ds_read_b128 v[144:147], v21 offset:0
  ds_read_b128 v[148:151], v21 offset:256
  ds_read_b128 v[152:155], v22 offset:0
  ds_read_b128 v[156:159], v22 offset:256
  ds_read_b128 v[160:163], v23 offset:0
  ds_read_b128 v[164:167], v23 offset:256
  s_waitcnt lgkmcnt(7)
  v_mfma_f32_16x16x32_bf16 v[80:83], v[88:91], v[136:139], v[80:83]
  s_waitcnt lgkmcnt(6)
  v_mfma_f32_16x16x32_bf16 v[84:87], v[88:91], v[140:143], v[84:87]
  s_waitcnt lgkmcnt(5)
  v_mfma_f32_16x16x32_bf16 v[80:83], v[92:95], v[144:147], v[80:83]
  s_waitcnt lgkmcnt(4)
  v_mfma_f32_16x16x32_bf16 v[84:87], v[92:95], v[148:151], v[84:87]
  s_waitcnt lgkmcnt(3)
  v_mfma_f32_16x16x32_bf16 v[80:83], v[96:99], v[152:155], v[80:83]
  s_waitcnt lgkmcnt(2)
  v_mfma_f32_16x16x32_bf16 v[84:87], v[96:99], v[156:159], v[84:87]
  s_waitcnt lgkmcnt(1)
  v_mfma_f32_16x16x32_bf16 v[80:83], v[100:103], v[160:163], v[80:83]
  s_waitcnt lgkmcnt(0)
  v_mfma_f32_16x16x32_bf16 v[84:87], v[100:103], v[164:167], v[84:87]
  ds_read_b128 v[76:79], v25
  s_waitcnt lgkmcnt(0)
  v_and_b32 v72, v76, v26
  v_and_b32 v73, v77, v26
  v_and_b32 v74, v78, v26
  v_and_b32 v75, v79, v26
  v_sub_f32 v76, v76, v72
  v_sub_f32 v77, v77, v73
  v_sub_f32 v78, v78, v74
  v_sub_f32 v79, v79, v75
  v_perm_b32 v88, v76, v76, v27
  v_perm_b32 v89, v76, v76, v28
  v_perm_b32 v90, v76, v76, v29
  v_perm_b32 v91, v76, v76, v30
  v_perm_b32 v92, v77, v77, v27
  v_perm_b32 v93, v77, v77, v28
  v_perm_b32 v94, v77, v77, v29
  v_perm_b32 v95, v77, v77, v30
  v_perm_b32 v96, v78, v78, v27
  v_perm_b32 v97, v78, v78, v28
  v_perm_b32 v98, v78, v78, v29
  v_perm_b32 v99, v78, v78, v30
  v_perm_b32 v100, v79, v79, v27
  v_perm_b32 v101, v79, v79, v28
  v_perm_b32 v102, v79, v79, v29
  v_perm_b32 v103, v79, v79, v30
  s_cmp_lg_u32 s59, 0
  s_cbranch_scc1 L_fin
  s_waitcnt vmcnt(7)
  v_mfma_f32_16x16x32_bf16 v[80:83], v[88:91], v[104:107], v[80:83]
  s_waitcnt vmcnt(6)
  v_mfma_f32_16x16x32_bf16 v[84:87], v[88:91], v[108:111], v[84:87]
  s_waitcnt vmcnt(5)
  v_mfma_f32_16x16x32_bf16 v[80:83], v[92:95], v[112:115], v[80:83]
  s_waitcnt vmcnt(4)
  v_mfma_f32_16x16x32_bf16 v[84:87], v[92:95], v[116:119], v[84:87]
  s_waitcnt vmcnt(3)
  v_mfma_f32_16x16x32_bf16 v[80:83], v[96:99], v[120:123], v[80:83]
  s_waitcnt vmcnt(2)
  v_mfma_f32_16x16x32_bf16 v[84:87], v[96:99], v[124:127], v[84:87]
  s_waitcnt vmcnt(1)
  v_mfma_f32_16x16x32_bf16 v[80:83], v[100:103], v[128:131], v[80:83]
  s_waitcnt vmcnt(0)
  v_mfma_f32_16x16x32_bf16 v[84:87], v[100:103], v[132:135], v[84:87]
  s_nop 7
  v_permlane32_swap_b32 v80, v84
  v_permlane32_swap_b32 v81, v85
  v_permlane32_swap_b32 v82, v86
  v_permlane32_swap_b32 v83, v87
  v_pk_add_f32 v[80:81], v[80:81], v[84:85]
  v_pk_add_f32 v[82:83], v[82:83], v[86:87]
  ds_write_b128 v1, v[80:83]
  ds_write_b32 v42, v2
  s_waitcnt lgkmcnt(0)
  s_endpgm
L_pb8:
  s_branch L_pb7
L_put:
  v_lshrrev_b32 v38, v0, v37
  v_lshlrev_b32 v38, 1, v38
  v_bfi_b32 v168, 1, v168, v38
  s_branch L_pu2
L_fin:
  ds_read2st64_b32 v[52:53], v41 offset0:1 offset1:4
  ds_read_b32 v38, v2 offset:1024
  ds_read_b128 v[64:67], v1
  s_waitcnt lgkmcnt(2)
  v_readfirstlane_b32 s37, v52
  v_readfirstlane_b32 s58, v53
  s_cmp_ge_i32 s37, 1000
  s_waitcnt lgkmcnt(0)
  s_cbranch_scc0 L_fin
  v_add_f32 v37, v38, v37
  s_bitcmp1_b32 s58, 15
  v_lshrrev_b32 v38, v0, v37
  v_lshlrev_b32 v38, 1, v38
  v_bfi_b32 v168, 1, v168, v38
  s_waitcnt vmcnt(7)
  v_mfma_f32_16x16x32_bf16 v[80:83], v[88:91], v[104:107], v[80:83]
  s_waitcnt vmcnt(6)
  v_mfma_f32_16x16x32_bf16 v[84:87], v[88:91], v[108:111], v[84:87]
  s_waitcnt vmcnt(5)
  v_mfma_f32_16x16x32_bf16 v[80:83], v[92:95], v[112:115], v[80:83]
  s_waitcnt vmcnt(4)
  v_mfma_f32_16x16x32_bf16 v[84:87], v[92:95], v[116:119], v[84:87]
  s_waitcnt vmcnt(3)
  v_mfma_f32_16x16x32_bf16 v[80:83], v[96:99], v[120:123], v[80:83]
  s_waitcnt vmcnt(2)
  v_mfma_f32_16x16x32_bf16 v[84:87], v[96:99], v[124:127], v[84:87]
  s_waitcnt vmcnt(1)
  v_mfma_f32_16x16x32_bf16 v[80:83], v[100:103], v[128:131], v[80:83]
  s_waitcnt vmcnt(0)
  v_mfma_f32_16x16x32_bf16 v[84:87], v[100:103], v[132:135], v[84:87]
  s_nop 7
  v_permlane32_swap_b32 v80, v84
  v_permlane32_swap_b32 v81, v85
  v_permlane32_swap_b32 v82, v86
  v_permlane32_swap_b32 v83, v87
  v_pk_add_f32 v[80:81], v[80:81], v[84:85]
  v_pk_add_f32 v[82:83], v[82:83], v[86:87]
  v_pk_add_f32 v[80:81], v[80:81], v[64:65]
  v_pk_add_f32 v[82:83], v[82:83], v[66:67]
L_pu2:
  v_bfi_b32 v84, 3, v168, v80
  v_bfi_b32 v85, 1, v169, v81
  v_bfi_b32 v86, 1, v170, v82
  v_bfi_b32 v87, 1, v171, v83
  s_cbranch_scc0 L_far
  buffer_store_dwordx4 v[84:87], v45, s[8:11], s72 offen
  s_endpgm
L_far:
  buffer_store_dwordx4 v[84:87], v45, s[8:11], s72 offen sc1
  s_lshl_b32 s38, 0x101, s31
  s_waitcnt vmcnt(0)
L_mark:
  v_mov_b32 v44, s38
  s_mov_b64 exec, 1
  global_atomic_or v44, v46, v44, s[56:57] offset:4 sc0 sc1
  s_mov_b64 exec, -1
  s_waitcnt vmcnt(0)
  v_readfirstlane_b32 s39, v44
  s_or_b32 s38, s38, s39
  s_and_b32 s39, s38, 0xff
  s_cmp_lg_u32 s39, 0xff
  s_cbranch_scc1 L_done
L_poll:
  global_load_dword v44, v46, s[56:57] offset:4 sc1
  buffer_load_dwordx4 v[140:143], v45, s[8:11], s73 offen sc1
  buffer_load_dwordx4 v[144:147], v45, s[8:11], s74 offen sc1
  buffer_load_dwordx4 v[148:151], v45, s[8:11], s75 offen sc1
  buffer_load_dwordx4 v[152:155], v45, s[8:11], s76 offen sc1
  buffer_load_dwordx4 v[156:159], v45, s[8:11], s77 offen sc1
  buffer_load_dwordx4 v[160:163], v45, s[8:11], s78 offen sc1
  buffer_load_dwordx4 v[164:167], v45, s[8:11], s79 offen sc1
  s_lshr_b32 s38, s38, s31
  s_bfe_i32 s49, s38, 0x10001
  s_bfe_i32 s50, s38, 0x10002
  s_bfe_i32 s51, s38, 0x10003
  s_bfe_i32 s52, s38, 0x10004
  s_bfe_i32 s53, s38, 0x10005
  s_bfe_i32 s54, s38, 0x10006
  s_bfe_i32 s55, s38, 0x10007
  v_mov_b32 v39, 1
  v_add_f32 v40, 0x358637bd, v37
  s_waitcnt vmcnt(7)
  v_readfirstlane_b32 s38, v44
  s_waitcnt vmcnt(6)
  v_and_b32 v38, 2, v140
  v_cmp_ne_u32 vcc, 0, v38
  v_xor_b32 v89, v140, v172
  v_bitop3_b32 v89, v89, v141, v173 bitop3:0x60
  v_bitop3_b32 v89, v89, v142, v174 bitop3:0x60
  v_bitop3_b32 v89, v89, v143, v175 bitop3:0x60
  v_add_f32 v40, vcc_lo, v40
  v_bitop3_b32 v39, v39, v89, s49 bitop3:0xe0
  v_or_b32 v140, 1, v140
  v_or_b32 v141, 1, v141
  v_or_b32 v142, 1, v142
  v_or_b32 v143, 1, v143
  v_add_f32 v136, v80, v140
  v_add_f32 v137, v81, v141
  v_add_f32 v138, v82, v142
  v_add_f32 v139, v83, v143
  s_waitcnt vmcnt(5)
  v_and_b32 v38, 2, v144
  v_cmp_ne_u32 vcc, 0, v38
  v_xor_b32 v90, v144, v176
  v_bitop3_b32 v90, v90, v145, v177 bitop3:0x60
  v_bitop3_b32 v90, v90, v146, v178 bitop3:0x60
  v_bitop3_b32 v90, v90, v147, v179 bitop3:0x60
  v_add_f32 v40, vcc_lo, v40
  v_bitop3_b32 v39, v39, v90, s50 bitop3:0xe0
  v_or_b32 v144, 1, v144
  v_or_b32 v145, 1, v145
  v_or_b32 v146, 1, v146
  v_or_b32 v147, 1, v147
  v_add_f32 v136, v136, v144
  v_add_f32 v137, v137, v145
  v_add_f32 v138, v138, v146
  v_add_f32 v139, v139, v147
  s_waitcnt vmcnt(4)
  v_and_b32 v38, 2, v148
  v_cmp_ne_u32 vcc, 0, v38
  v_xor_b32 v91, v148, v180
  v_bitop3_b32 v91, v91, v149, v181 bitop3:0x60
  v_bitop3_b32 v91, v91, v150, v182 bitop3:0x60
  v_bitop3_b32 v91, v91, v151, v183 bitop3:0x60
  v_add_f32 v40, vcc_lo, v40
  v_bitop3_b32 v39, v39, v91, s51 bitop3:0xe0
  v_or_b32 v148, 1, v148
  v_or_b32 v149, 1, v149
  v_or_b32 v150, 1, v150
  v_or_b32 v151, 1, v151
  v_add_f32 v136, v136, v148
  v_add_f32 v137, v137, v149
  v_add_f32 v138, v138, v150
  v_add_f32 v139, v139, v151
  s_waitcnt vmcnt(3)
  v_and_b32 v38, 2, v152
  v_cmp_ne_u32 vcc, 0, v38
  v_xor_b32 v92, v152, v184
  v_bitop3_b32 v92, v92, v153, v185 bitop3:0x60
  v_bitop3_b32 v92, v92, v154, v186 bitop3:0x60
  v_bitop3_b32 v92, v92, v155, v187 bitop3:0x60
  v_add_f32 v40, vcc_lo, v40
  v_bitop3_b32 v39, v39, v92, s52 bitop3:0xe0
  v_or_b32 v152, 1, v152
  v_or_b32 v153, 1, v153
  v_or_b32 v154, 1, v154
  v_or_b32 v155, 1, v155
  v_add_f32 v136, v136, v152
  v_add_f32 v137, v137, v153
  v_add_f32 v138, v138, v154
  v_add_f32 v139, v139, v155
  s_waitcnt vmcnt(2)
  v_and_b32 v38, 2, v156
  v_cmp_ne_u32 vcc, 0, v38
  v_xor_b32 v93, v156, v188
  v_bitop3_b32 v93, v93, v157, v189 bitop3:0x60
  v_bitop3_b32 v93, v93, v158, v190 bitop3:0x60
  v_bitop3_b32 v93, v93, v159, v191 bitop3:0x60
  v_add_f32 v40, vcc_lo, v40
  v_bitop3_b32 v39, v39, v93, s53 bitop3:0xe0
  v_or_b32 v156, 1, v156
  v_or_b32 v157, 1, v157
  v_or_b32 v158, 1, v158
  v_or_b32 v159, 1, v159
  v_add_f32 v136, v136, v156
  v_add_f32 v137, v137, v157
  v_add_f32 v138, v138, v158
  v_add_f32 v139, v139, v159
  s_waitcnt vmcnt(1)
  v_and_b32 v38, 2, v160
  v_cmp_ne_u32 vcc, 0, v38
  v_xor_b32 v94, v160, v192
  v_bitop3_b32 v94, v94, v161, v193 bitop3:0x60
  v_bitop3_b32 v94, v94, v162, v194 bitop3:0x60
  v_bitop3_b32 v94, v94, v163, v195 bitop3:0x60
  v_add_f32 v40, vcc_lo, v40
  v_bitop3_b32 v39, v39, v94, s54 bitop3:0xe0
  v_or_b32 v160, 1, v160
  v_or_b32 v161, 1, v161
  v_or_b32 v162, 1, v162
  v_or_b32 v163, 1, v163
  v_add_f32 v136, v136, v160
  v_add_f32 v137, v137, v161
  v_add_f32 v138, v138, v162
  v_add_f32 v139, v139, v163
  s_waitcnt vmcnt(0)
  v_and_b32 v38, 2, v164
  v_cmp_ne_u32 vcc, 0, v38
  v_xor_b32 v95, v164, v196
  v_bitop3_b32 v95, v95, v165, v197 bitop3:0x60
  v_bitop3_b32 v95, v95, v166, v198 bitop3:0x60
  v_bitop3_b32 v95, v95, v167, v199 bitop3:0x60
  v_add_f32 v40, vcc_lo, v40
  v_bitop3_b32 v39, v39, v95, s55 bitop3:0xe0
  v_or_b32 v164, 1, v164
  v_or_b32 v165, 1, v165
  v_or_b32 v166, 1, v166
  v_or_b32 v167, 1, v167
  v_add_f32 v136, v136, v164
  v_add_f32 v137, v137, v165
  v_add_f32 v138, v138, v166
  v_add_f32 v139, v139, v167
  v_cmp_eq_u32 vcc, 0, v39
  s_nop 4
  s_cbranch_vccnz L_poll
L_div:
  v_rcp_f32 v64, v40
  s_nop 0
  v_fma_f32 v65, -v40, v64, 1.0
  v_fmac_f32 v64, v65, v64
  v_mul_f32 v72, v136, v64
  v_mul_f32 v73, v137, v64
  v_mul_f32 v74, v138, v64
  v_mul_f32 v75, v139, v64
  v_fma_f32 v76, -v40, v72, v136
  v_fma_f32 v77, -v40, v73, v137
  v_fma_f32 v78, -v40, v74, v138
  v_fma_f32 v79, -v40, v75, v139
  v_fmac_f32 v72, v76, v64
  v_fmac_f32 v73, v77, v64
  v_fmac_f32 v74, v78, v64
  v_fmac_f32 v75, v79, v64
  v_div_fixup_f32 v72, v72, v40, v136
  v_div_fixup_f32 v73, v73, v40, v137
  v_div_fixup_f32 v74, v74, v40, v138
  v_div_fixup_f32 v75, v75, v40, v139
  v_cvt_pk_bf16_f32 v72, v72, v73
  v_cvt_pk_bf16_f32 v73, v74, v75
  buffer_store_dwordx2 v[72:73], v3, s[4:7], 0 offen
L_done:
L_end:
  s_endpgm
.section .rodata,"a"
.p2align 6
.amdhsa_kernel standalone__linear_kernel_rfa__decode_kernel
  .amdhsa_next_free_vgpr 200
  .amdhsa_next_free_sgpr 90
  .amdhsa_accum_offset 200
  .amdhsa_group_segment_fixed_size 0
  .amdhsa_kernarg_size 56
  .amdhsa_user_sgpr_count 2
  .amdhsa_user_sgpr_kernarg_segment_ptr 1
  .amdhsa_system_sgpr_workgroup_id_x 1
  .amdhsa_float_denorm_mode_32 3
.end_amdhsa_kernel
```
